```python
import torch

def _softmax(x, axis=-1):
    return torch.softmax(x, dim=axis)
def _gelu(x):
    return torch.nn.functional.gelu(x, approximate="tanh")
def _silu(x):
    return torch.nn.functional.silu(x)
def _sigmoid(x):
    return torch.sigmoid(x)
def _layernorm(x, axis=-1, eps=1e-5):
    m = x.mean(dim=axis, keepdim=True)
    v = x.var(dim=axis, keepdim=True, unbiased=False)
    return (x - m) / torch.sqrt(v + eps)
def _scatter_add(tgt, idx, src, axis=0):
    return tgt.clone().index_add_(axis, idx, src)
def _segment_sum(src, seg, n):
    out = torch.zeros((n,) + src.shape[1:], dtype=src.dtype)
    return out.index_add_(0, seg, src)
def _pad(x, pw):
    flat = tuple(v for pair in reversed(pw) for v in pair)
    return torch.nn.functional.pad(x, flat)

kernel_name = 'recurrent_scan__ssm_conv_s4d__mixer_channel_mlp__prompt'

def setup_inputs():

    _w = (lambda a: (lambda t: t.to(torch.bfloat16) if t.is_floating_point() else t)(torch.as_tensor(a)))
    def _A_setup():
        Bsz, L, D, N = 1, 2048, 448, 256
        return {
            "u": _w((lambda *s: torch.randn(*s, dtype=torch.bfloat16) * 0.05)(Bsz, L, D)),
            "log_A_real": _w((lambda *s: torch.randn(*s, dtype=torch.bfloat16) * 3.2)(D, N) * 0.5),
            "A_imag": _w((lambda *s: torch.randn(*s, dtype=torch.bfloat16) * 0.2)(D, N) * 3.14),
            "C_real": _w((lambda *s: torch.randn(*s, dtype=torch.bfloat16) * 0.8)(D, N) / N ** 0.5),
            "C_imag": _w((lambda *s: torch.randn(*s, dtype=torch.bfloat16) * 0.8)(D, N) / N ** 0.5),
            "log_dt": _w((lambda *s: torch.randn(*s, dtype=torch.bfloat16) * 0.2)(D) * 0.5 - 4.0),
            "D_skip": _w((lambda *s: torch.randn(*s, dtype=torch.bfloat16) * 0.2)(D)),
        }
    _A_in = _A_setup()

    def _B_setup():
        B, S, D, F = 1, 2048, 448, 1792
        return {
            "x": _w((lambda *s: torch.randn(*s, dtype=torch.bfloat16) * 0.05)(B, S, D)),
            "w1": _w((lambda *s: torch.randn(*s, dtype=torch.bfloat16) * 1.6)(D, F) * (D ** -0.5)),
            "b1": _w((lambda *s: torch.randn(*s, dtype=torch.bfloat16) * 0.8)(F)),
            "w2": _w((lambda *s: torch.randn(*s, dtype=torch.bfloat16) * 0.1)(F, D) * (F ** -0.5)),
            "b2": _w((lambda *s: torch.randn(*s, dtype=torch.bfloat16) * 0.1)(D)),
        }
    _B_in = _B_setup()

    return {
        "A_u": _A_in["u"],
        "A_log_A_real": _A_in["log_A_real"],
        "A_A_imag": _A_in["A_imag"],
        "A_C_real": _A_in["C_real"],
        "A_C_imag": _A_in["C_imag"],
        "A_log_dt": _A_in["log_dt"],
        "A_D_skip": _A_in["D_skip"],
        "B_x": _B_in["x"],
        "B_w1": _B_in["w1"],
        "B_b1": _B_in["b1"],
        "B_w2": _B_in["w2"],
        "B_b2": _B_in["b2"],
    }

def reference(A_u, A_log_A_real, A_A_imag, A_C_real, A_C_imag, A_log_dt, A_D_skip, B_x, B_w1, B_b1, B_w2, B_b2):
    def _A_ref(u, log_A_real, A_imag, C_real, C_imag, log_dt, D_skip):
        L = u.shape[1]
        dt = torch.exp(log_dt)
        A = -torch.exp(log_A_real) + 1j * A_imag
        C = (C_real + 1j * C_imag) * dt[:, None]
        pos = (lambda x, dt: x.to(dt))(torch.arange(L), log_dt.dtype)
        P = torch.exp((A * dt[:, None])[:, :, None] * pos[None, None, :])
        K = 2.0 * torch.einsum("dn,dnl->dl", C, P).real
        L2 = 2 * L
        u_t = (lambda x, *d: x.permute(*d))(u, 0, 2, 1)
        Kf = (lambda x, *a, **k: torch.fft.rfft(x.float(), *a, **k))(K, L2)
        Uf = (lambda x, *a, **k: torch.fft.rfft(x.float(), *a, **k))(u_t, L2)
        y = (lambda x, *a, **k: torch.fft.irfft(x, *a, **k).to(torch.bfloat16))(Uf * Kf[None, :, :], L2)[:, :, :L]
        y = (lambda x, *d: x.permute(*d))(y, 0, 2, 1)
        return y + u * D_skip[None, None, :]

    def _B_ref(x, w1, b1, w2, b2):
        y = _layernorm(x, axis=-1)
        h = _gelu(torch.einsum("bsd,df->bsf", y, w1) + b1)
        return torch.einsum("bsf,fd->bsd", h, w2) + b2

    x = A_u
    xn = _layernorm(x, axis=-1)
    s = _A_ref(xn, A_log_A_real, A_A_imag, A_C_real, A_C_imag, A_log_dt, A_D_skip)
    g = _silu(_B_ref(xn, B_w1, B_b1, B_w2, B_b2))
    return x + s * g
```

```asm
; @launch grid=(256,1,1) block=(512,1,1) lds=163840
.amdgcn_target "amdgcn-amd-amdhsa--gfx950"
.text
.globl recurrent_scan__ssm_conv_s4d__mixer_channel_mlp__prompt_kernel
.p2align 8
.type recurrent_scan__ssm_conv_s4d__mixer_channel_mlp__prompt_kernel,@function
recurrent_scan__ssm_conv_s4d__mixer_channel_mlp__prompt_kernel:
L_START:
    s_load_dwordx2 s[48:49], s[0:1], 64
    s_load_dwordx2 s[52:53], s[0:1], 0
    s_load_dwordx16 s[16:31], s[0:1], 0
    s_load_dwordx8 s[32:39], s[0:1], 64
    s_load_dwordx4 s[40:43], s[0:1], 96
    s_load_dwordx2 s[44:45], s[0:1], 112
    v_lshrrev_b32 v1, 6, v0
    v_and_b32 v0, 63, v0
    s_cmp_ge_u32 s2, 256
    v_readfirstlane_b32 s3, v1
    s_cbranch_scc1 recurrent_scan__ssm_conv_s4d__mixer_channel_mlp__prompt_kernel_END
    s_and_b32 s78, s2, 7
    s_lshr_b32 s79, s2, 3
    s_mov_b32 s69, 0x40000
    s_cmp_lt_u32 s79, 28
    s_cbranch_scc1 L_NOPF
    s_sub_u32 s10, s79, 28
    s_lshl_b32 s10, s10, 3
    s_add_u32 s10, s10, s3
    s_lshl_b32 s10, s10, 7
    s_getpc_b64 s[14:15]
L_PC:
    v_lshl_add_u32 v2, v0, 12, s10
    s_sub_u32 s14, s14, (L_PC - L_START)
    s_subb_u32 s15, s15, 0
    v_min_u32 v2, (L_CODE_END - L_START - 4), v2
    v_mov_b32 v3, s15
    v_add_co_u32 v2, vcc, s14, v2
    s_nop 1
    v_addc_co_u32 v3, vcc, 0, v3, vcc
    global_load_dword v251, v[2:3], off
L_NOPF:
    s_cmp_ge_u32 s79, 28
    s_cbranch_scc1 R_SPARE
    s_cmp_ge_u32 s3, 4
    s_cbranch_scc1 R_KC
    s_mul_i32 s6, s79, 37
    s_lshr_b32 s6, s6, 8
    s_mul_i32 s7, s6, 7
    s_sub_u32 s7, s79, s7
    s_lshr_b32 s4, s6, 1
    s_lshl_b32 s70, s78, 1
    s_add_u32 s70, s70, s4
    s_and_b32 s5, s6, 1
    s_mul_i32 s71, s5, 7
    s_add_u32 s71, s71, s7
    s_lshl_b32 s72, s78, 2
    s_add_u32 s72, s72, s6
    s_mov_b32 s73, s7
    s_lshl_b32 s8, s6, 1
    s_add_u32 s80, s8, s7
    s_cmp_ge_u32 s80, 7
    s_cselect_b32 s9, 7, 0
    s_sub_u32 s80, s80, s9
    s_lshl_b32 s74, s3, 11
    s_lshl_b32 s75, s3, 12
    s_add_u32 s75, s75, 49152
    s_and_b32 s77, s3, 1
    s_lshr_b32 s68, s3, 1
    s_mov_b32 s50, 0x188000
    s_mov_b32 s51, 0x00020000
    s_mov_b32 s54, 0x1c0000
    s_mov_b32 s55, 0x00020000
    v_lshrrev_b32 v1, 4, v0
    v_and_b32 v16, 15, v0
    v_lshlrev_b32 v17, 2, v1
    v_xor_b32 v16, v16, v17
    v_mul_u32_u24 v2, 3584, v1
    v_lshl_add_u32 v2, v16, 4, v2
    s_lshl_b32 s10, s71, 8
    s_mul_i32 s11, s3, 28672
    s_add_u32 s10, s10, s11
    v_add_u32 v2, s10, v2
    v_add_u32 v3, 13312, v2
    v_and_b32 v16, 7, v0
    v_xor_b32 v16, v16, v1
    v_lshrrev_b32 v17, 3, v0
    v_mul_u32_u24 v17, 896, v17
    v_lshl_add_u32 v4, v16, 4, v17
    s_lshl_b32 s10, s70, 7
    s_lshl_b32 s11, s3, 5
    s_add_u32 s10, s10, s11
    s_mul_i32 s10, s10, 896
    v_add_u32 v4, s10, v4
    v_xor_b32 v5, 64, v4
    v_add_u32 v6, 12288, v4
    v_add_u32 v7, 18432, v5
    v_add_u32 v5, 6144, v5
    s_add_u32 s81, s80, 1
    s_cmp_eq_u32 s81, 7
    s_cselect_b32 s81, 0, s81
    s_add_u32 s82, s81, 1
    s_cmp_eq_u32 s82, 7
    s_cselect_b32 s82, 0, s82
    s_add_u32 s83, s82, 1
    s_cmp_eq_u32 s83, 7
    s_cselect_b32 s83, 0, s83
    s_add_u32 s84, s83, 1
    s_cmp_eq_u32 s84, 7
    s_cselect_b32 s84, 0, s84
    s_add_u32 s85, s84, 1
    s_cmp_eq_u32 s85, 7
    s_cselect_b32 s85, 0, s85
    s_add_u32 s86, s85, 1
    s_cmp_eq_u32 s86, 7
    s_cselect_b32 s86, 0, s86
    s_lshl_b32 s10, s71, 8
    s_lshl_b32 s11, s77, 7
    s_add_u32 s10, s10, s11
    v_lshl_add_u32 v20, v0, 1, s10
    s_lshl_b32 s10, s73, 7
    v_lshl_add_u32 v21, v0, 1, s10
    v_lshrrev_b32 v16, 1, v1
    v_bfe_u32 v17, v0, 2, 2
    v_lshl_add_u32 v18, v16, 3, v17
    v_lshlrev_b32 v18, 8, v18
    v_and_b32 v19, 1, v0
    v_lshl_add_u32 v18, v19, 3, v18
    v_and_b32 v19, 1, v1
    v_lshlrev_b32 v19, 1, v19
    v_bfe_u32 v22, v0, 1, 1
    v_add_u32 v19, v19, v22
    s_lshl_b32 s10, s77, 3
    v_add_u32 v19, s10, v19
    v_lshlrev_b32 v17, 2, v17
    v_xor_b32 v22, v19, v17
    v_lshl_add_u32 v8, v22, 4, v18
    v_xor_b32 v9, 64, v8
    v_and_b32 v16, 31, v0
    v_lshrrev_b32 v17, 5, v0
    v_bfe_u32 v18, v0, 1, 3
    v_xor_b32 v17, v17, v18
    v_lshlrev_b32 v16, 7, v16
    v_lshl_add_u32 v16, v17, 4, v16
    s_lshl_b32 s10, s68, 13
    s_add_u32 s10, s10, 49152
    v_add_u32 v10, s10, v16
    v_xor_b32 v11, 32, v10
    v_xor_b32 v12, 64, v10
    v_xor_b32 v13, 96, v10
    s_waitcnt lgkmcnt(0)
    s_mul_i32 s8, s80, 229376
    s_add_u32 m0, s74, 0
    s_nop 0
    buffer_load_dwordx4 v2, s[48:51], s8 offen lds
    buffer_load_dwordx4 v3, s[48:51], s8 offen offset:1024 lds
    s_lshl_b32 s9, s80, 7
    s_add_u32 m0, s75, 0
    s_nop 0
    buffer_load_dwordx4 v4, s[52:55], s9 offen lds
    buffer_load_dwordx4 v5, s[52:55], s9 offen offset:1024 lds
    s_add_u32 m0, s75, 0
    s_nop 0
    buffer_load_dwordx4 v6, s[52:55], s9 offen offset:2048 lds
    buffer_load_dwordx4 v7, s[52:55], s9 offen offset:3072 lds
    s_add_u32 s8, s8, 114688
    s_add_u32 m0, s74, 8192
    s_nop 0
    buffer_load_dwordx4 v2, s[48:51], s8 offen lds
    buffer_load_dwordx4 v3, s[48:51], s8 offen offset:1024 lds
    s_barrier
    global_load_ushort v250, v20, s[34:35]
    global_load_ushort v251, v21, s[38:39]
    s_mul_i32 s8, s81, 229376
    s_add_u32 m0, s74, 16384
    s_nop 0
    buffer_load_dwordx4 v2, s[48:51], s8 offen lds
    buffer_load_dwordx4 v3, s[48:51], s8 offen offset:1024 lds
    s_add_u32 s8, s8, 114688
    s_add_u32 m0, s74, 24576
    s_nop 0
    buffer_load_dwordx4 v2, s[48:51], s8 offen lds
    buffer_load_dwordx4 v3, s[48:51], s8 offen offset:1024 lds
    s_mov_b32 s56, s44
    s_mov_b32 s57, s45
    s_mov_b32 s58, 0x1000000
    s_mov_b32 s59, 0x00020000
    s_mov_b32 s64, s36
    s_mov_b32 s65, s37
    s_mov_b32 s66, 0x188000
    s_mov_b32 s67, 0x00020000
    s_mov_b32 s60, s40
    s_mov_b32 s61, s41
    s_mov_b32 s62, 0x1c0000
    s_mov_b32 s63, 0x00020000
    v_and_b32 v16, 3, v0
    v_lshlrev_b32 v16, 2, v16
    v_add_u32 v248, 138752, v16
    v_lshlrev_b32 v16, 2, v0
    v_add_u32 v14, 163584, v16
    s_lshl_b32 s10, s3, 2
    s_add_u32 s10, s10, 138752
    v_writelane_b32 v14, s10, 0
    v_mov_b32 v15, 1
    v_and_b32 v16, 3, v0
    v_and_b32 v17, 1, v1
    v_xor_b32 v16, v16, v17
    v_mov_b32 v17, 0x3f803f80
    v_cmp_eq_u32 vcc, 0, v16
    s_nop 1
    v_cndmask_b32 v80, 0, v17, vcc
    v_cmp_eq_u32 vcc, 2, v16
    s_nop 1
    v_cndmask_b32 v84, 0, v17, vcc
    v_mov_b32 v81, v80
    v_mov_b32 v85, v84
    v_mov_b32 v82, v80
    v_mov_b32 v86, v84
    v_mov_b32 v83, v80
    v_mov_b32 v87, v84
    v_lshrrev_b32 v16, 3, v0
    v_and_b32 v17, 7, v0
    v_bfe_u32 v18, v0, 4, 1
    v_lshlrev_b32 v18, 2, v18
    v_xor_b32 v17, v17, v18
    v_mul_u32_u24 v16, 896, v16
    v_lshl_add_u32 v252, v17, 4, v16
    s_mul_i32 s10, s3, 401408
    s_lshl_b32 s11, s73, 7
    s_add_u32 s10, s10, s11
    v_add_u32 v252, s10, v252
    v_add_u32 v253, 6144, v252
    v_lshrrev_b32 v16, 1, v1
    v_bfe_u32 v17, v0, 2, 2
    v_lshl_add_u32 v18, v16, 2, v17
    v_lshlrev_b32 v18, 7, v18
    v_and_b32 v19, 1, v0
    v_lshl_add_u32 v18, v19, 3, v18
    v_add_u32 v18, s74, v18
    v_and_b32 v19, 1, v1
    v_lshlrev_b32 v19, 1, v19
    v_bfe_u32 v20, v0, 1, 1
    v_add_u32 v19, v19, v20
    v_bfe_u32 v20, v0, 3, 1
    v_lshlrev_b32 v20, 2, v20
    v_xor_b32 v19, v19, v20
    v_lshl_add_u32 v254, v19, 4, v18
    s_lshl_b32 s12, s70, 2
    s_lshl_b32 s13, s68, 1
    s_add_u32 s12, s12, s13
    s_mul_i32 s12, s12, 112
    s_lshl_b32 s13, s71, 3
    s_add_u32 s12, s12, s13
    s_lshl_b32 s13, s77, 2
    s_add_u32 s12, s12, s13
    s_lshl_b32 s76, s12, 10
    s_mul_i32 s12, s72, 224
    s_mul_i32 s13, s3, 28
    s_add_u32 s12, s12, s13
    s_lshl_b32 s12, s12, 10
    s_lshl_b32 s13, s80, 12
    s_add_u32 s87, s12, s13
    s_lshl_b32 s13, s81, 12
    s_add_u32 s88, s12, s13
    s_lshl_b32 s13, s82, 12
    s_add_u32 s89, s12, s13
    s_lshl_b32 s13, s83, 12
    s_add_u32 s90, s12, s13
    s_lshl_b32 s13, s84, 12
    s_add_u32 s91, s12, s13
    s_lshl_b32 s13, s85, 12
    s_add_u32 s92, s12, s13
    s_lshl_b32 s13, s86, 12
    s_add_u32 s93, s12, s13
    s_getreg_b32 s15, hwreg(HW_REG_XCC_ID)
    s_lshl_b32 s10, s78, 8
    s_add_u32 s10, s10, 11059200
    v_min_u32 v234, 27, v0
    v_lshl_add_u32 v234, v234, 3, s10
    v_mov_b32 v94, 138784
    s_setprio 2
    s_lshl_b32 s9, s81, 7
    s_add_u32 m0, s75, 16384
    s_nop 0
    buffer_load_dwordx4 v4, s[52:55], s9 offen lds
    buffer_load_dwordx4 v5, s[52:55], s9 offen offset:1024 lds
    s_add_u32 m0, s75, 16384
    s_nop 0
    buffer_load_dwordx4 v6, s[52:55], s9 offen offset:2048 lds
    buffer_load_dwordx4 v7, s[52:55], s9 offen offset:3072 lds
    s_waitcnt vmcnt(10)
    ds_write_b32 v14, v15
SPIN_1:
    s_sub_u32 s69, s69, 1
    s_cbranch_scc1 recurrent_scan__ssm_conv_s4d__mixer_channel_mlp__prompt_kernel_BAIL
    ds_read_b32 v249, v248 offset:0
    s_waitcnt lgkmcnt(0)
    v_cmp_gt_u32 vcc, 1, v249
    s_cbranch_vccnz SPIN_1
    ds_read_b64_tr_b16 v[16:17], v8 offset:0
    ds_read_b64_tr_b16 v[18:19], v8 offset:1024
    ds_read_b64_tr_b16 v[20:21], v9 offset:0
    ds_read_b64_tr_b16 v[22:23], v9 offset:1024
    ds_read_b128 v[24:27], v10 offset:0
    ds_read_b128 v[28:31], v10 offset:4096
    ds_read_b64_tr_b16 v[32:33], v8 offset:4096
    ds_read_b64_tr_b16 v[34:35], v8 offset:5120
    ds_read_b64_tr_b16 v[36:37], v9 offset:4096
    ds_read_b64_tr_b16 v[38:39], v9 offset:5120
    ds_read_b128 v[40:43], v11 offset:0
    ds_read_b128 v[44:47], v11 offset:4096
    s_waitcnt lgkmcnt(6)
    v_mfma_f32_32x32x16_bf16 v[128:143], v[16:19], v[24:27], 0
    ds_read_b32 v249, v248
    v_mfma_f32_32x32x16_bf16 v[144:159], v[16:19], v[28:31], 0
    v_mfma_f32_16x16x32_bf16 v[88:91], v[80:83], v[16:19], 0
    s_waitcnt lgkmcnt(0)
    v_cmp_gt_u32 vcc, 1, v249
    s_cbranch_vccnz CF_2
CFB_3:
    s_mul_i32 s8, s82, 229376
    s_add_u32 m0, s74, 32768
    s_nop 0
    buffer_load_dwordx4 v2, s[48:51], s8 offen lds
    buffer_load_dwordx4 v3, s[48:51], s8 offen offset:1024 lds
    v_mfma_f32_32x32x16_bf16 v[160:175], v[20:23], v[24:27], 0
    ds_read_b64_tr_b16 v[48:49], v8 offset:8192
    ds_read_b64_tr_b16 v[50:51], v8 offset:9216
    v_mfma_f32_16x16x32_bf16 v[88:91], v[84:87], v[20:23], v[88:91]
    ds_read_b64_tr_b16 v[52:53], v9 offset:8192
    ds_read_b64_tr_b16 v[54:55], v9 offset:9216
    s_lshl_b32 s9, s82, 7
    s_add_u32 m0, s75, 32768
    s_nop 0
    buffer_load_dwordx4 v4, s[52:55], s9 offen lds
    v_mfma_f32_32x32x16_bf16 v[176:191], v[20:23], v[28:31], 0
    ds_read_b128 v[56:59], v12 offset:0
    ds_read_b128 v[60:63], v12 offset:4096
    s_waitcnt lgkmcnt(7)
    v_mfma_f32_32x32x16_bf16 v[128:143], v[32:35], v[40:43], v[128:143]
    ds_read_b64_tr_b16 v[64:65], v8 offset:12288
    ds_read_b64_tr_b16 v[66:67], v8 offset:13312
    buffer_load_dwordx4 v5, s[52:55], s9 offen offset:1024 lds
    v_mfma_f32_16x16x32_bf16 v[88:91], v[80:83], v[32:35], v[88:91]
    ds_read_b64_tr_b16 v[68:69], v9 offset:12288
    ds_read_b64_tr_b16 v[70:71], v9 offset:13312
    v_mfma_f32_32x32x16_bf16 v[144:159], v[32:35], v[44:47], v[144:159]
    ds_read_b128 v[72:75], v13 offset:0
    ds_read_b128 v[76:79], v13 offset:4096
    s_add_u32 m0, s75, 32768
    s_nop 0
    buffer_load_dwordx4 v6, s[52:55], s9 offen offset:2048 lds
    s_waitcnt vmcnt(5)
    v_add_u32 v15, 1, v15
    ds_write_b32 v14, v15
    v_mfma_f32_16x16x32_bf16 v[88:91], v[84:87], v[36:39], v[88:91]
    v_mfma_f32_32x32x16_bf16 v[160:175], v[36:39], v[40:43], v[160:175]
    buffer_load_dwordx4 v7, s[52:55], s9 offen offset:3072 lds
    v_mfma_f32_32x32x16_bf16 v[176:191], v[36:39], v[44:47], v[176:191]
    s_waitcnt lgkmcnt(7)
    v_mfma_f32_32x32x16_bf16 v[128:143], v[48:51], v[56:59], v[128:143]
    ds_read_b32 v249, v248
    s_add_u32 s8, s8, 114688
    s_add_u32 m0, s74, 40960
    s_nop 0
    buffer_load_dwordx4 v2, s[48:51], s8 offen lds
    v_mfma_f32_32x32x16_bf16 v[144:159], v[48:51], v[60:63], v[144:159]
    v_mfma_f32_16x16x32_bf16 v[88:91], v[80:83], v[48:51], v[88:91]
    s_waitcnt lgkmcnt(0)
    v_cmp_gt_u32 vcc, 2, v249
    s_cbranch_vccnz CF_4
CFB_5:
    v_mfma_f32_32x32x16_bf16 v[160:175], v[52:55], v[56:59], v[160:175]
    ds_read_b64_tr_b16 v[16:17], v8 offset:16384
    ds_read_b64_tr_b16 v[18:19], v8 offset:17408
    buffer_load_dwordx4 v3, s[48:51], s8 offen offset:1024 lds
    v_mfma_f32_16x16x32_bf16 v[88:91], v[84:87], v[52:55], v[88:91]
    ds_read_b64_tr_b16 v[20:21], v9 offset:16384
    ds_read_b64_tr_b16 v[22:23], v9 offset:17408
    v_mfma_f32_32x32x16_bf16 v[176:191], v[52:55], v[60:63], v[176:191]
    ds_read_b128 v[24:27], v10 offset:16384
    ds_read_b128 v[28:31], v10 offset:20480
    s_waitcnt lgkmcnt(8)
    v_mfma_f32_32x32x16_bf16 v[128:143], v[64:67], v[72:75], v[128:143]
    ds_read_b64_tr_b16 v[32:33], v8 offset:20480
    ds_read_b64_tr_b16 v[34:35], v8 offset:21504
    s_lshl_b32 s9, s83, 7
    s_add_u32 m0, s75, 49152
    s_nop 0
    buffer_load_dwordx4 v4, s[52:55], s9 offen lds
    v_mfma_f32_16x16x32_bf16 v[88:91], v[80:83], v[64:67], v[88:91]
    ds_read_b64_tr_b16 v[36:37], v9 offset:20480
    ds_read_b64_tr_b16 v[38:39], v9 offset:21504
    v_mfma_f32_32x32x16_bf16 v[144:159], v[64:67], v[76:79], v[144:159]
    ds_read_b128 v[40:43], v11 offset:16384
    ds_read_b128 v[44:47], v11 offset:20480
    s_waitcnt vmcnt(9)
    v_add_u32 v15, 1, v15
    ds_write_b32 v14, v15
    v_mfma_f32_16x16x32_bf16 v[88:91], v[84:87], v[68:71], v[88:91]
    buffer_load_dwordx4 v5, s[52:55], s9 offen offset:1024 lds
    v_mfma_f32_32x32x16_bf16 v[160:175], v[68:71], v[72:75], v[160:175]
    v_mfma_f32_32x32x16_bf16 v[176:191], v[68:71], v[76:79], v[176:191]
    s_waitcnt lgkmcnt(7)
    v_mfma_f32_32x32x16_bf16 v[128:143], v[16:19], v[24:27], v[128:143]
    ds_read_b32 v249, v248
    s_mul_i32 s8, s83, 229376
    s_add_u32 m0, s74, 0
    s_nop 0
    buffer_load_dwordx4 v2, s[48:51], s8 offen lds
    v_mfma_f32_32x32x16_bf16 v[144:159], v[16:19], v[28:31], v[144:159]
    v_mfma_f32_16x16x32_bf16 v[88:91], v[80:83], v[16:19], v[88:91]
    s_waitcnt lgkmcnt(0)
    v_cmp_gt_u32 vcc, 3, v249
    s_cbranch_vccnz CF_6
CFB_7:
    v_mfma_f32_32x32x16_bf16 v[160:175], v[20:23], v[24:27], v[160:175]
    ds_read_b64_tr_b16 v[48:49], v8 offset:24576
    ds_read_b64_tr_b16 v[50:51], v8 offset:25600
    buffer_load_dwordx4 v3, s[48:51], s8 offen offset:1024 lds
    v_mfma_f32_16x16x32_bf16 v[88:91], v[84:87], v[20:23], v[88:91]
    ds_read_b64_tr_b16 v[52:53], v9 offset:24576
    ds_read_b64_tr_b16 v[54:55], v9 offset:25600
    v_mfma_f32_32x32x16_bf16 v[176:191], v[20:23], v[28:31], v[176:191]
    ds_read_b128 v[56:59], v12 offset:16384
    ds_read_b128 v[60:63], v12 offset:20480
    s_waitcnt lgkmcnt(8)
    v_mfma_f32_32x32x16_bf16 v[128:143], v[32:35], v[40:43], v[128:143]
    ds_read_b64_tr_b16 v[64:65], v8 offset:28672
    ds_read_b64_tr_b16 v[66:67], v8 offset:29696
    s_add_u32 m0, s75, 49152
    s_nop 0
    buffer_load_dwordx4 v6, s[52:55], s9 offen offset:2048 lds
    v_mfma_f32_16x16x32_bf16 v[88:91], v[80:83], v[32:35], v[88:91]
    ds_read_b64_tr_b16 v[68:69], v9 offset:28672
    ds_read_b64_tr_b16 v[70:71], v9 offset:29696
    v_mfma_f32_32x32x16_bf16 v[144:159], v[32:35], v[44:47], v[144:159]
    ds_read_b128 v[72:75], v13 offset:16384
    ds_read_b128 v[76:79], v13 offset:20480
    s_waitcnt vmcnt(7)
    v_add_u32 v15, 1, v15
    ds_write_b32 v14, v15
    v_mfma_f32_16x16x32_bf16 v[88:91], v[84:87], v[36:39], v[88:91]
    buffer_load_dwordx4 v7, s[52:55], s9 offen offset:3072 lds
    v_mfma_f32_32x32x16_bf16 v[160:175], v[36:39], v[40:43], v[160:175]
    v_mfma_f32_32x32x16_bf16 v[176:191], v[36:39], v[44:47], v[176:191]
    s_waitcnt lgkmcnt(7)
    v_mfma_f32_32x32x16_bf16 v[128:143], v[48:51], v[56:59], v[128:143]
    ds_read_b32 v249, v248
    s_add_u32 s8, s8, 114688
    s_add_u32 m0, s74, 8192
    s_nop 0
    buffer_load_dwordx4 v2, s[48:51], s8 offen lds
    v_mfma_f32_32x32x16_bf16 v[144:159], v[48:51], v[60:63], v[144:159]
    v_mfma_f32_16x16x32_bf16 v[88:91], v[80:83], v[48:51], v[88:91]
    s_waitcnt lgkmcnt(0)
    v_cmp_gt_u32 vcc, 4, v249
    s_cbranch_vccnz CF_8
CFB_9:
    v_mfma_f32_32x32x16_bf16 v[160:175], v[52:55], v[56:59], v[160:175]
    ds_read_b64_tr_b16 v[16:17], v8 offset:32768
    ds_read_b64_tr_b16 v[18:19], v8 offset:33792
    buffer_load_dwordx4 v3, s[48:51], s8 offen offset:1024 lds
    v_mfma_f32_16x16x32_bf16 v[88:91], v[84:87], v[52:55], v[88:91]
    ds_read_b64_tr_b16 v[20:21], v9 offset:32768
    ds_read_b64_tr_b16 v[22:23], v9 offset:33792
    v_mfma_f32_32x32x16_bf16 v[176:191], v[52:55], v[60:63], v[176:191]
    ds_read_b128 v[24:27], v10 offset:32768
    ds_read_b128 v[28:31], v10 offset:36864
    s_waitcnt lgkmcnt(8)
    v_mfma_f32_32x32x16_bf16 v[128:143], v[64:67], v[72:75], v[128:143]
    ds_read_b64_tr_b16 v[32:33], v8 offset:36864
    ds_read_b64_tr_b16 v[34:35], v8 offset:37888
    s_lshl_b32 s9, s84, 7
    s_add_u32 m0, s75, 0
    s_nop 0
    buffer_load_dwordx4 v4, s[52:55], s9 offen lds
    v_mfma_f32_16x16x32_bf16 v[88:91], v[80:83], v[64:67], v[88:91]
    ds_read_b64_tr_b16 v[36:37], v9 offset:36864
    ds_read_b64_tr_b16 v[38:39], v9 offset:37888
    v_mfma_f32_32x32x16_bf16 v[144:159], v[64:67], v[76:79], v[144:159]
    ds_read_b128 v[40:43], v11 offset:32768
    ds_read_b128 v[44:47], v11 offset:36864
    s_waitcnt vmcnt(9)
    v_add_u32 v15, 1, v15
    ds_write_b32 v14, v15
    v_mfma_f32_16x16x32_bf16 v[88:91], v[84:87], v[68:71], v[88:91]
    buffer_load_dwordx4 v5, s[52:55], s9 offen offset:1024 lds
    v_mfma_f32_32x32x16_bf16 v[160:175], v[68:71], v[72:75], v[160:175]
    v_mfma_f32_32x32x16_bf16 v[176:191], v[68:71], v[76:79], v[176:191]
    s_waitcnt lgkmcnt(7)
    v_mfma_f32_32x32x16_bf16 v[128:143], v[16:19], v[24:27], v[128:143]
    ds_read_b32 v249, v248
    s_mul_i32 s8, s84, 229376
    s_add_u32 m0, s74, 16384
    s_nop 0
    buffer_load_dwordx4 v2, s[48:51], s8 offen lds
    v_mfma_f32_32x32x16_bf16 v[144:159], v[16:19], v[28:31], v[144:159]
    v_mfma_f32_16x16x32_bf16 v[88:91], v[80:83], v[16:19], v[88:91]
    s_waitcnt lgkmcnt(0)
    v_cmp_gt_u32 vcc, 5, v249
    s_cbranch_vccnz CF_10
CFB_11:
    v_mfma_f32_32x32x16_bf16 v[160:175], v[20:23], v[24:27], v[160:175]
    ds_read_b64_tr_b16 v[48:49], v8 offset:40960
    ds_read_b64_tr_b16 v[50:51], v8 offset:41984
    buffer_load_dwordx4 v3, s[48:51], s8 offen offset:1024 lds
    v_mfma_f32_16x16x32_bf16 v[88:91], v[84:87], v[20:23], v[88:91]
    ds_read_b64_tr_b16 v[52:53], v9 offset:40960
    ds_read_b64_tr_b16 v[54:55], v9 offset:41984
    v_mfma_f32_32x32x16_bf16 v[176:191], v[20:23], v[28:31], v[176:191]
    ds_read_b128 v[56:59], v12 offset:32768
    ds_read_b128 v[60:63], v12 offset:36864
    s_waitcnt lgkmcnt(8)
    v_mfma_f32_32x32x16_bf16 v[128:143], v[32:35], v[40:43], v[128:143]
    ds_read_b64_tr_b16 v[64:65], v8 offset:45056
    ds_read_b64_tr_b16 v[66:67], v8 offset:46080
    s_add_u32 m0, s75, 0
    s_nop 0
    buffer_load_dwordx4 v6, s[52:55], s9 offen offset:2048 lds
    v_mfma_f32_16x16x32_bf16 v[88:91], v[80:83], v[32:35], v[88:91]
    ds_read_b64_tr_b16 v[68:69], v9 offset:45056
    ds_read_b64_tr_b16 v[70:71], v9 offset:46080
    v_mfma_f32_32x32x16_bf16 v[144:159], v[32:35], v[44:47], v[144:159]
    ds_read_b128 v[72:75], v13 offset:32768
    ds_read_b128 v[76:79], v13 offset:36864
    s_waitcnt vmcnt(7)
    v_add_u32 v15, 1, v15
    ds_write_b32 v14, v15
    v_mfma_f32_16x16x32_bf16 v[88:91], v[84:87], v[36:39], v[88:91]
    buffer_load_dwordx4 v7, s[52:55], s9 offen offset:3072 lds
    v_mfma_f32_32x32x16_bf16 v[160:175], v[36:39], v[40:43], v[160:175]
    v_mfma_f32_32x32x16_bf16 v[176:191], v[36:39], v[44:47], v[176:191]
    s_waitcnt lgkmcnt(7)
    v_mfma_f32_32x32x16_bf16 v[128:143], v[48:51], v[56:59], v[128:143]
    ds_read_b32 v249, v248
    s_add_u32 s8, s8, 114688
    s_add_u32 m0, s74, 24576
    s_nop 0
    buffer_load_dwordx4 v2, s[48:51], s8 offen lds
    v_mfma_f32_32x32x16_bf16 v[144:159], v[48:51], v[60:63], v[144:159]
    v_mfma_f32_16x16x32_bf16 v[88:91], v[80:83], v[48:51], v[88:91]
    s_waitcnt lgkmcnt(0)
    v_cmp_gt_u32 vcc, 6, v249
    s_cbranch_vccnz CF_12
CFB_13:
    v_mfma_f32_32x32x16_bf16 v[160:175], v[52:55], v[56:59], v[160:175]
    ds_read_b64_tr_b16 v[16:17], v8 offset:0
    ds_read_b64_tr_b16 v[18:19], v8 offset:1024
    buffer_load_dwordx4 v3, s[48:51], s8 offen offset:1024 lds
    v_mfma_f32_16x16x32_bf16 v[88:91], v[84:87], v[52:55], v[88:91]
    ds_read_b64_tr_b16 v[20:21], v9 offset:0
    ds_read_b64_tr_b16 v[22:23], v9 offset:1024
    v_mfma_f32_32x32x16_bf16 v[176:191], v[52:55], v[60:63], v[176:191]
    ds_read_b128 v[24:27], v10 offset:49152
    ds_read_b128 v[28:31], v10 offset:53248
    s_waitcnt lgkmcnt(8)
    v_mfma_f32_32x32x16_bf16 v[128:143], v[64:67], v[72:75], v[128:143]
    ds_read_b64_tr_b16 v[32:33], v8 offset:4096
    ds_read_b64_tr_b16 v[34:35], v8 offset:5120
    s_lshl_b32 s9, s85, 7
    s_add_u32 m0, s75, 16384
    s_nop 0
    buffer_load_dwordx4 v4, s[52:55], s9 offen lds
    v_mfma_f32_16x16x32_bf16 v[88:91], v[80:83], v[64:67], v[88:91]
    ds_read_b64_tr_b16 v[36:37], v9 offset:4096
    ds_read_b64_tr_b16 v[38:39], v9 offset:5120
    v_mfma_f32_32x32x16_bf16 v[144:159], v[64:67], v[76:79], v[144:159]
    ds_read_b128 v[40:43], v11 offset:49152
    ds_read_b128 v[44:47], v11 offset:53248
    s_waitcnt vmcnt(9)
    v_add_u32 v15, 1, v15
    ds_write_b32 v14, v15
    v_mfma_f32_16x16x32_bf16 v[88:91], v[84:87], v[68:71], v[88:91]
    buffer_load_dwordx4 v5, s[52:55], s9 offen offset:1024 lds
    v_mfma_f32_32x32x16_bf16 v[160:175], v[68:71], v[72:75], v[160:175]
    v_mfma_f32_32x32x16_bf16 v[176:191], v[68:71], v[76:79], v[176:191]
    s_waitcnt lgkmcnt(7)
    v_mfma_f32_32x32x16_bf16 v[128:143], v[16:19], v[24:27], v[128:143]
    ds_read_b32 v249, v248
    s_mul_i32 s8, s85, 229376
    s_add_u32 m0, s74, 32768
    s_nop 0
    buffer_load_dwordx4 v2, s[48:51], s8 offen lds
    v_mfma_f32_32x32x16_bf16 v[144:159], v[16:19], v[28:31], v[144:159]
    v_mfma_f32_16x16x32_bf16 v[88:91], v[80:83], v[16:19], v[88:91]
    s_waitcnt lgkmcnt(0)
    v_cmp_gt_u32 vcc, 7, v249
    s_cbranch_vccnz CF_14
CFB_15:
    v_mfma_f32_32x32x16_bf16 v[160:175], v[20:23], v[24:27], v[160:175]
    ds_read_b64_tr_b16 v[48:49], v8 offset:8192
    ds_read_b64_tr_b16 v[50:51], v8 offset:9216
    buffer_load_dwordx4 v3, s[48:51], s8 offen offset:1024 lds
    v_mfma_f32_16x16x32_bf16 v[88:91], v[84:87], v[20:23], v[88:91]
    ds_read_b64_tr_b16 v[52:53], v9 offset:8192
    ds_read_b64_tr_b16 v[54:55], v9 offset:9216
    v_mfma_f32_32x32x16_bf16 v[176:191], v[20:23], v[28:31], v[176:191]
    ds_read_b128 v[56:59], v12 offset:49152
    ds_read_b128 v[60:63], v12 offset:53248
    s_waitcnt lgkmcnt(8)
    v_mfma_f32_32x32x16_bf16 v[128:143], v[32:35], v[40:43], v[128:143]
    ds_read_b64_tr_b16 v[64:65], v8 offset:12288
    ds_read_b64_tr_b16 v[66:67], v8 offset:13312
    s_add_u32 m0, s75, 16384
    s_nop 0
    buffer_load_dwordx4 v6, s[52:55], s9 offen offset:2048 lds
    v_mfma_f32_16x16x32_bf16 v[88:91], v[80:83], v[32:35], v[88:91]
    ds_read_b64_tr_b16 v[68:69], v9 offset:12288
    ds_read_b64_tr_b16 v[70:71], v9 offset:13312
    v_mfma_f32_32x32x16_bf16 v[144:159], v[32:35], v[44:47], v[144:159]
    ds_read_b128 v[72:75], v13 offset:49152
    ds_read_b128 v[76:79], v13 offset:53248
    s_waitcnt vmcnt(7)
    v_add_u32 v15, 1, v15
    ds_write_b32 v14, v15
    v_mfma_f32_16x16x32_bf16 v[88:91], v[84:87], v[36:39], v[88:91]
    buffer_load_dwordx4 v7, s[52:55], s9 offen offset:3072 lds
    v_mfma_f32_32x32x16_bf16 v[160:175], v[36:39], v[40:43], v[160:175]
    v_mfma_f32_32x32x16_bf16 v[176:191], v[36:39], v[44:47], v[176:191]
    s_waitcnt lgkmcnt(7)
    v_mfma_f32_32x32x16_bf16 v[128:143], v[48:51], v[56:59], v[128:143]
    ds_read_b32 v249, v248
    s_add_u32 s8, s8, 114688
    s_add_u32 m0, s74, 40960
    s_nop 0
    buffer_load_dwordx4 v2, s[48:51], s8 offen lds
    v_mfma_f32_32x32x16_bf16 v[144:159], v[48:51], v[60:63], v[144:159]
    v_mfma_f32_16x16x32_bf16 v[88:91], v[80:83], v[48:51], v[88:91]
    s_waitcnt lgkmcnt(0)
    v_cmp_gt_u32 vcc, 8, v249
    s_cbranch_vccnz CF_16
CFB_17:
    v_mfma_f32_32x32x16_bf16 v[160:175], v[52:55], v[56:59], v[160:175]
    ds_read_b64_tr_b16 v[16:17], v8 offset:16384
    ds_read_b64_tr_b16 v[18:19], v8 offset:17408
    buffer_load_dwordx4 v3, s[48:51], s8 offen offset:1024 lds
    v_mfma_f32_16x16x32_bf16 v[88:91], v[84:87], v[52:55], v[88:91]
    ds_read_b64_tr_b16 v[20:21], v9 offset:16384
    ds_read_b64_tr_b16 v[22:23], v9 offset:17408
    v_mfma_f32_32x32x16_bf16 v[176:191], v[52:55], v[60:63], v[176:191]
    ds_read_b128 v[24:27], v10 offset:0
    ds_read_b128 v[28:31], v10 offset:4096
    s_waitcnt lgkmcnt(8)
    v_mfma_f32_32x32x16_bf16 v[128:143], v[64:67], v[72:75], v[128:143]
    ds_read_b64_tr_b16 v[32:33], v8 offset:20480
    ds_read_b64_tr_b16 v[34:35], v8 offset:21504
    s_lshl_b32 s9, s86, 7
    s_add_u32 m0, s75, 32768
    s_nop 0
    buffer_load_dwordx4 v4, s[52:55], s9 offen lds
    v_mfma_f32_16x16x32_bf16 v[88:91], v[80:83], v[64:67], v[88:91]
    ds_read_b64_tr_b16 v[36:37], v9 offset:20480
    ds_read_b64_tr_b16 v[38:39], v9 offset:21504
    v_mfma_f32_32x32x16_bf16 v[144:159], v[64:67], v[76:79], v[144:159]
    ds_read_b128 v[40:43], v11 offset:0
    ds_read_b128 v[44:47], v11 offset:4096
    s_waitcnt vmcnt(9)
    v_add_u32 v15, 1, v15
    ds_write_b32 v14, v15
    v_mfma_f32_16x16x32_bf16 v[88:91], v[84:87], v[68:71], v[88:91]
    buffer_load_dwordx4 v5, s[52:55], s9 offen offset:1024 lds
    v_mfma_f32_32x32x16_bf16 v[160:175], v[68:71], v[72:75], v[160:175]
    v_mfma_f32_32x32x16_bf16 v[176:191], v[68:71], v[76:79], v[176:191]
    s_waitcnt lgkmcnt(7)
    v_mfma_f32_32x32x16_bf16 v[128:143], v[16:19], v[24:27], v[128:143]
    ds_read_b32 v249, v248
    s_mul_i32 s8, s86, 229376
    s_add_u32 m0, s74, 0
    s_nop 0
    buffer_load_dwordx4 v2, s[48:51], s8 offen lds
    v_mfma_f32_32x32x16_bf16 v[144:159], v[16:19], v[28:31], v[144:159]
    buffer_load_dwordx4 v3, s[48:51], s8 offen offset:1024 lds
    v_mfma_f32_16x16x32_bf16 v[88:91], v[80:83], v[16:19], v[88:91]
    s_waitcnt lgkmcnt(0)
    v_cmp_gt_u32 vcc, 9, v249
    s_cbranch_vccnz CF_18
CFB_19:
    v_mfma_f32_32x32x16_bf16 v[160:175], v[20:23], v[24:27], v[160:175]
    ds_read_b64_tr_b16 v[48:49], v8 offset:24576
    ds_read_b64_tr_b16 v[50:51], v8 offset:25600
    s_add_u32 m0, s75, 32768
    s_nop 0
    buffer_load_dwordx4 v6, s[52:55], s9 offen offset:2048 lds
    v_mfma_f32_16x16x32_bf16 v[88:91], v[84:87], v[20:23], v[88:91]
    ds_read_b64_tr_b16 v[52:53], v9 offset:24576
    ds_read_b64_tr_b16 v[54:55], v9 offset:25600
    buffer_load_dwordx4 v7, s[52:55], s9 offen offset:3072 lds
    v_mfma_f32_32x32x16_bf16 v[176:191], v[20:23], v[28:31], v[176:191]
    ds_read_b128 v[56:59], v12 offset:0
    ds_read_b128 v[60:63], v12 offset:4096
    s_waitcnt lgkmcnt(8)
    v_mfma_f32_32x32x16_bf16 v[128:143], v[32:35], v[40:43], v[128:143]
    ds_read_b64_tr_b16 v[64:65], v8 offset:28672
    ds_read_b64_tr_b16 v[66:67], v8 offset:29696
    s_mul_i32 s11, s80, 57344
    s_add_u32 m0, s74, 98304
    s_nop 0
    buffer_load_dwordx4 v252, s[64:67], s11 offen lds
    v_mfma_f32_16x16x32_bf16 v[88:91], v[80:83], v[32:35], v[88:91]
    ds_read_b64_tr_b16 v[68:69], v9 offset:28672
    ds_read_b64_tr_b16 v[70:71], v9 offset:29696
    buffer_load_dwordx4 v253, s[64:67], s11 offen offset:1024 lds
    v_mfma_f32_32x32x16_bf16 v[144:159], v[32:35], v[44:47], v[144:159]
    ds_read_b128 v[72:75], v13 offset:0
    ds_read_b128 v[76:79], v13 offset:4096
    s_waitcnt vmcnt(10)
    v_add_u32 v15, 1, v15
    ds_write_b32 v14, v15
    v_mfma_f32_16x16x32_bf16 v[88:91], v[84:87], v[36:39], v[88:91]
    s_mul_i32 s11, s80, 57344
    s_add_u32 s11, s11, 14336
    s_add_u32 m0, s74, 106496
    s_nop 0
    buffer_load_dwordx4 v252, s[64:67], s11 offen lds
    v_mfma_f32_32x32x16_bf16 v[160:175], v[36:39], v[40:43], v[160:175]
    buffer_load_dwordx4 v253, s[64:67], s11 offen offset:1024 lds
    v_mfma_f32_32x32x16_bf16 v[176:191], v[36:39], v[44:47], v[176:191]
    s_waitcnt lgkmcnt(7)
    v_mfma_f32_32x32x16_bf16 v[128:143], v[48:51], v[56:59], v[128:143]
    ds_read_b32 v249, v248
    s_add_u32 s8, s8, 114688
    s_add_u32 m0, s74, 8192
    s_nop 0
    buffer_load_dwordx4 v2, s[48:51], s8 offen lds
    v_mfma_f32_32x32x16_bf16 v[144:159], v[48:51], v[60:63], v[144:159]
    v_and_b32 v96, 15, v0
    v_mfma_f32_16x16x32_bf16 v[88:91], v[80:83], v[48:51], v[88:91]
    s_waitcnt lgkmcnt(0)
    v_cmp_gt_u32 vcc, 10, v249
    s_cbranch_vccnz CF_20
CFB_21:
    v_lshrrev_b32 v97, 4, v0
    v_mfma_f32_32x32x16_bf16 v[160:175], v[52:55], v[56:59], v[160:175]
    ds_read_b64_tr_b16 v[16:17], v8 offset:32768
    ds_read_b64_tr_b16 v[18:19], v8 offset:33792
    buffer_load_dwordx4 v3, s[48:51], s8 offen offset:1024 lds
    s_lshl_b32 s4, s72, 6
    ds_read_b64 v[92:93], v94
    v_mfma_f32_16x16x32_bf16 v[88:91], v[84:87], v[52:55], v[88:91]
    ds_read_b64_tr_b16 v[20:21], v9 offset:32768
    ds_read_b64_tr_b16 v[22:23], v9 offset:33792
    s_lshl_b32 s5, s3, 4
    v_mfma_f32_32x32x16_bf16 v[176:191], v[52:55], v[60:63], v[176:191]
    ds_read_b128 v[24:27], v10 offset:16384
    ds_read_b128 v[28:31], v10 offset:20480
    s_add_u32 s4, s4, s5
    s_waitcnt lgkmcnt(9)
    v_mfma_f32_32x32x16_bf16 v[128:143], v[64:67], v[72:75], v[128:143]
    ds_read_b64_tr_b16 v[32:33], v8 offset:36864
    ds_read_b64_tr_b16 v[34:35], v8 offset:37888
    s_mul_i32 s11, s81, 57344
    s_add_u32 m0, s74, 16384
    s_nop 0
    buffer_load_dwordx4 v252, s[64:67], s11 offen lds
    v_add_u32 v98, s4, v96
    v_mfma_f32_16x16x32_bf16 v[88:91], v[80:83], v[64:67], v[88:91]
    ds_read_b64_tr_b16 v[36:37], v9 offset:36864
    ds_read_b64_tr_b16 v[38:39], v9 offset:37888
    v_mul_u32_u24 v98, 896, v98
    v_mfma_f32_32x32x16_bf16 v[144:159], v[64:67], v[76:79], v[144:159]
    ds_read_b128 v[40:43], v11 offset:16384
    ds_read_b128 v[44:47], v11 offset:20480
    s_waitcnt vmcnt(13)
    v_add_u32 v15, 1, v15
    ds_write_b32 v14, v15
    v_lshl_add_u32 v98, v97, 4, v98
    v_mfma_f32_16x16x32_bf16 v[88:91], v[84:87], v[68:71], v[88:91]
    buffer_load_dwordx4 v253, s[64:67], s11 offen offset:1024 lds
    s_lshl_b32 s5, s73, 7
    v_mfma_f32_32x32x16_bf16 v[160:175], v[68:71], v[72:75], v[160:175]
    v_add_u32 v4, s5, v98
    s_waitcnt lgkmcnt(11)
TGB_23:
    v_cmp_eq_u32 vcc, 0, v93
    s_cbranch_vccnz TG_22
    v_readfirstlane_b32 s46, v92
    s_mul_i32 s47, s46, 0x9E3779B1
    s_add_u32 s47, s47, 0x7F4A7C15
    v_mfma_f32_32x32x16_bf16 v[176:191], v[68:71], v[76:79], v[176:191]
    s_waitcnt lgkmcnt(7)
    v_mfma_f32_32x32x16_bf16 v[128:143], v[16:19], v[24:27], v[128:143]
    ds_read_b32 v249, v248
    v_mfma_f32_32x32x16_bf16 v[144:159], v[16:19], v[28:31], v[144:159]
    v_lshrrev_b32 v98, 3, v0
    v_mfma_f32_16x16x32_bf16 v[88:91], v[80:83], v[16:19], v[88:91]
    s_waitcnt lgkmcnt(0)
    v_cmp_gt_u32 vcc, 11, v249
    s_cbranch_vccnz CF_24
CFB_25:
    s_mul_i32 s11, s81, 57344
    s_add_u32 s11, s11, 14336
    s_add_u32 m0, s74, 49152
    s_nop 0
    buffer_load_dwordx4 v252, s[64:67], s11 offen lds
    buffer_load_dwordx4 v253, s[64:67], s11 offen offset:1024 lds
    v_and_b32 v99, 7, v0
    v_mfma_f32_32x32x16_bf16 v[160:175], v[20:23], v[24:27], v[160:175]
    ds_read_b64_tr_b16 v[48:49], v8 offset:40960
    ds_read_b64_tr_b16 v[50:51], v8 offset:41984
    s_lshl_b32 s4, s73, 6
    v_mfma_f32_16x16x32_bf16 v[88:91], v[84:87], v[20:23], v[88:91]
    ds_read_b64_tr_b16 v[52:53], v9 offset:40960
    ds_read_b64_tr_b16 v[54:55], v9 offset:41984
    s_mul_i32 s11, s82, 57344
    s_add_u32 m0, s74, 57344
    s_nop 0
    buffer_load_dwordx4 v252, s[64:67], s11 offen lds
    s_lshl_b32 s5, s3, 4
    v_mfma_f32_32x32x16_bf16 v[176:191], v[20:23], v[28:31], v[176:191]
    ds_read_b128 v[56:59], v12 offset:16384
    ds_read_b128 v[60:63], v12 offset:20480
    s_add_u32 s4, s4, s5
    s_waitcnt lgkmcnt(8)
    v_mfma_f32_32x32x16_bf16 v[128:143], v[32:35], v[40:43], v[128:143]
    ds_read_b64_tr_b16 v[64:65], v8 offset:45056
    ds_read_b64_tr_b16 v[66:67], v8 offset:46080
    buffer_load_dwordx4 v253, s[64:67], s11 offen offset:1024 lds
    v_add_u32 v100, s4, v98
    v_mfma_f32_16x16x32_bf16 v[88:91], v[80:83], v[32:35], v[88:91]
    ds_read_b64_tr_b16 v[68:69], v9 offset:45056
    ds_read_b64_tr_b16 v[70:71], v9 offset:46080
    v_lshlrev_b32 v100, 12, v100
    v_mfma_f32_32x32x16_bf16 v[144:159], v[32:35], v[44:47], v[144:159]
    ds_read_b128 v[72:75], v13 offset:16384
    ds_read_b128 v[76:79], v13 offset:20480
    s_mul_i32 s11, s82, 57344
    s_add_u32 s11, s11, 14336
    s_add_u32 m0, s74, 24576
    s_nop 0
    buffer_load_dwordx4 v252, s[64:67], s11 offen lds
    s_waitcnt vmcnt(13)
    v_add_u32 v15, 1, v15
    ds_write_b32 v14, v15
    v_lshl_add_u32 v5, v99, 4, v100
    v_mfma_f32_16x16x32_bf16 v[88:91], v[84:87], v[36:39], v[88:91]
    s_lshl_b32 s10, s70, 7
    s_lshl_b32 s12, s68, 6
    s_add_u32 s10, s10, s12
    s_lshl_b32 s5, s72, 7
    v_mfma_f32_32x32x16_bf16 v[160:175], v[36:39], v[40:43], v[160:175]
    buffer_load_dwordx4 v253, s[64:67], s11 offen offset:1024 lds
    s_lshl_b32 s10, s10, 4
    s_add_u32 s10, s10, 11026432
    v_lshl_add_u32 v2, v0, 4, s10
    s_add_u32 s5, s5, 9175040
    v_mfma_f32_32x32x16_bf16 v[176:191], v[36:39], v[44:47], v[176:191]
    s_waitcnt lgkmcnt(7)
    v_mfma_f32_32x32x16_bf16 v[128:143], v[48:51], v[56:59], v[128:143]
    ds_read_b32 v249, v248
    v_mfma_f32_32x32x16_bf16 v[144:159], v[48:51], v[60:63], v[144:159]
    v_add_u32 v5, s5, v5
    v_mfma_f32_16x16x32_bf16 v[88:91], v[80:83], v[48:51], v[88:91]
    s_waitcnt lgkmcnt(0)
    v_cmp_gt_u32 vcc, 12, v249
    s_cbranch_vccnz CF_26
CFB_27:
    global_load_dwordx2 v[232:233], v234, s[44:45] sc1
    s_mul_i32 s4, s3, 28672
    v_mfma_f32_32x32x16_bf16 v[160:175], v[52:55], v[56:59], v[160:175]
    ds_read_b64_tr_b16 v[16:17], v8 offset:0
    ds_read_b64_tr_b16 v[18:19], v8 offset:1024
    global_load_dwordx4 v[192:195], v2, s[44:45] sc1
    v_mul_u32_u24 v6, 144, v98
    v_mfma_f32_16x16x32_bf16 v[88:91], v[84:87], v[52:55], v[88:91]
    ds_read_b64_tr_b16 v[20:21], v9 offset:0
    ds_read_b64_tr_b16 v[22:23], v9 offset:1024
    v_lshl_add_u32 v6, v99, 4, v6
    v_mfma_f32_32x32x16_bf16 v[176:191], v[52:55], v[60:63], v[176:191]
    ds_read_b128 v[24:27], v10 offset:32768
    ds_read_b128 v[28:31], v10 offset:36864
    v_add_u32 v6, s4, v6
    s_waitcnt lgkmcnt(8)
    v_mfma_f32_32x32x16_bf16 v[128:143], v[64:67], v[72:75], v[128:143]
    ds_read_b64_tr_b16 v[32:33], v8 offset:4096
    ds_read_b64_tr_b16 v[34:35], v8 offset:5120
    s_mul_i32 s11, s83, 57344
    s_add_u32 m0, s74, 32768
    s_nop 0
    buffer_load_dwordx4 v252, s[64:67], s11 offen lds
    s_lshl_b32 s5, s73, 3
    v_mfma_f32_16x16x32_bf16 v[88:91], v[80:83], v[64:67], v[88:91]
    ds_read_b64_tr_b16 v[36:37], v9 offset:4096
    ds_read_b64_tr_b16 v[38:39], v9 offset:5120
    s_add_u32 s5, s5, s78
    v_mfma_f32_32x32x16_bf16 v[144:159], v[64:67], v[76:79], v[144:159]
    ds_read_b128 v[40:43], v11 offset:32768
    ds_read_b128 v[44:47], v11 offset:36864
    s_waitcnt vmcnt(11)
    v_add_u32 v15, 1, v15
    ds_write_b32 v14, v15
    s_lshl_b32 s5, s5, 7
    v_mfma_f32_16x16x32_bf16 v[88:91], v[84:87], v[68:71], v[88:91]
    buffer_load_dwordx4 v253, s[64:67], s11 offen offset:1024 lds
    s_add_u32 s5, s5, 11067392
    v_mfma_f32_32x32x16_bf16 v[160:175], v[68:71], v[72:75], v[160:175]
    v_mov_b32 v7, s5
    v_mfma_f32_32x32x16_bf16 v[176:191], v[68:71], v[76:79], v[176:191]
    s_waitcnt lgkmcnt(7)
    v_mfma_f32_32x32x16_bf16 v[128:143], v[16:19], v[24:27], v[128:143]
    ds_read_b32 v249, v248
    v_mfma_f32_32x32x16_bf16 v[144:159], v[16:19], v[28:31], v[144:159]
    v_mfma_f32_16x16x32_bf16 v[88:91], v[80:83], v[16:19], v[88:91]
    s_waitcnt lgkmcnt(0)
    v_cmp_gt_u32 vcc, 13, v249
    s_cbranch_vccnz CF_28
CFB_29:
    s_mul_i32 s11, s83, 57344
    s_add_u32 s11, s11, 14336
    s_add_u32 m0, s74, 40960
    s_nop 0
    buffer_load_dwordx4 v252, s[64:67], s11 offen lds
    buffer_load_dwordx4 v253, s[64:67], s11 offen offset:1024 lds
    v_mfma_f32_32x32x16_bf16 v[160:175], v[20:23], v[24:27], v[160:175]
    ds_read_b64_tr_b16 v[48:49], v8 offset:8192
    ds_read_b64_tr_b16 v[50:51], v8 offset:9216
    v_mfma_f32_16x16x32_bf16 v[88:91], v[84:87], v[20:23], v[88:91]
    ds_read_b64_tr_b16 v[52:53], v9 offset:8192
    ds_read_b64_tr_b16 v[54:55], v9 offset:9216
    s_mul_i32 s11, s84, 57344
    s_add_u32 m0, s74, 65536
    s_nop 0
    buffer_load_dwordx4 v252, s[64:67], s11 offen lds
    v_mfma_f32_32x32x16_bf16 v[176:191], v[20:23], v[28:31], v[176:191]
    ds_read_b128 v[56:59], v12 offset:32768
    ds_read_b128 v[60:63], v12 offset:36864
    s_waitcnt lgkmcnt(8)
    v_mfma_f32_32x32x16_bf16 v[128:143], v[32:35], v[40:43], v[128:143]
    ds_read_b64_tr_b16 v[64:65], v8 offset:12288
    ds_read_b64_tr_b16 v[66:67], v8 offset:13312
    buffer_load_dwordx4 v253, s[64:67], s11 offen offset:1024 lds
    v_mfma_f32_16x16x32_bf16 v[88:91], v[80:83], v[32:35], v[88:91]
    ds_read_b64_tr_b16 v[68:69], v9 offset:12288
    ds_read_b64_tr_b16 v[70:71], v9 offset:13312
    v_mfma_f32_32x32x16_bf16 v[144:159], v[32:35], v[44:47], v[144:159]
    ds_read_b128 v[72:75], v13 offset:32768
    ds_read_b128 v[76:79], v13 offset:36864
    s_mul_i32 s11, s84, 57344
    s_add_u32 s11, s11, 14336
    s_add_u32 m0, s74, 73728
    s_nop 0
    buffer_load_dwordx4 v252, s[64:67], s11 offen lds
    v_add_u32 v15, 1, v15
    ds_write_b32 v14, v15
    v_mfma_f32_16x16x32_bf16 v[88:91], v[84:87], v[36:39], v[88:91]
    v_mfma_f32_32x32x16_bf16 v[160:175], v[36:39], v[40:43], v[160:175]
    buffer_load_dwordx4 v253, s[64:67], s11 offen offset:1024 lds
    v_mfma_f32_32x32x16_bf16 v[176:191], v[36:39], v[44:47], v[176:191]
    s_waitcnt lgkmcnt(0)
    v_add_u32 v15, 1, v15
    ds_write_b32 v14, v15
    ds_read_b32 v249, v248
    v_mfma_f32_16x16x32_bf16 v[88:91], v[80:83], v[48:51], v[88:91]
    v_mfma_f32_16x16x32_bf16 v[88:91], v[84:87], v[52:55], v[88:91]
    v_mfma_f32_16x16x32_bf16 v[88:91], v[80:83], v[64:67], v[88:91]
    v_mfma_f32_16x16x32_bf16 v[88:91], v[84:87], v[68:71], v[88:91]
    s_waitcnt vmcnt(8)
    v_cmp_ne_u32 vcc, s47, v232
    s_or_b32 s10, vcc_lo, vcc_hi
    v_cmp_ne_u32 vcc, s15, v233
    s_or_b32 s10, s10, vcc_lo
    s_or_b32 s10, s10, vcc_hi
    s_cmp_eq_u32 s10, 0
    s_cselect_b32 s14, 1, 0
STB_31:
    v_xor_b32 v198, s47, v193
    v_xor_b32 v199, s47, v195
    v_or_b32 v198, v198, v199
    v_cmp_ne_u32 vcc, 0, v198
    s_cbranch_vccnz STP_30
    v_mfma_f32_32x32x16_bf16 v[128:143], v[48:51], v[56:59], v[128:143]
    v_mov_b32 v211, 0
    v_mov_b32 v215, 0
    v_mov_b32 v219, 0
    v_mov_b32 v223, 0
    v_mov_b32 v203, 0
    v_mov_b32 v202, v250
    s_waitcnt lgkmcnt(0)
    v_cmp_gt_u32 vcc, 14, v249
    s_cbranch_vccnz CF_32
CFB_33:
    s_mul_i32 s11, s85, 57344
    s_add_u32 m0, s74, 0
    s_nop 0
    buffer_load_dwordx4 v252, s[64:67], s11 offen lds
    buffer_load_dwordx4 v253, s[64:67], s11 offen offset:1024 lds
    v_mfma_f32_32x32x16_bf16 v[144:159], v[48:51], v[60:63], v[144:159]
    v_rcp_f32 v198, v192
    v_mul_f32 v232, v192, v192
    v_mul_f32 v229, 0x40135761, v192
    v_cvt_pk_bf16_f32 v205, v194, v198
    v_mul_f32 v232, v232, v192
    v_lshlrev_b32 v234, 16, v205
    ds_read_b32 v249, v248
    v_mfma_f32_32x32x16_bf16 v[160:175], v[52:55], v[56:59], v[160:175]
    v_and_b32 v233, 0xffff0000, v205
    v_mul_f32 v224, 0x3dd2d3e8, v232
    v_sub_f32 v234, v194, v234
    v_sub_f32 v233, v198, v233
    v_cvt_pk_bf16_f32 v204, v194, v234
    v_cvt_pk_bf16_f32 v206, v233, 0
    v_mov_b32 v228, v198
    v_mfma_f32_32x32x16_bf16 v[176:191], v[52:55], v[60:63], v[176:191]
    v_mov_b32 v226, v224
    v_mov_b32 v231, v229
    v_mov_b32 v230, v198
    v_permlane32_swap_b32 v224, v226
    v_permlane32_swap_b32 v229, v231
    v_permlane32_swap_b32 v228, v230
    v_mov_b32 v208, v204
    v_mov_b32 v196, v88
    s_nop 1
    v_mov_b32_dpp v196, v89 quad_perm:[0,1,2,3] row_mask:0x2 bank_mask:0xf
    s_nop 1
    v_mov_b32_dpp v196, v90 quad_perm:[0,1,2,3] row_mask:0x4 bank_mask:0xf
    s_nop 1
    v_mov_b32_dpp v196, v91 quad_perm:[0,1,2,3] row_mask:0x8 bank_mask:0xf
    v_mfma_f32_32x32x16_bf16 v[128:143], v[64:67], v[72:75], v[128:143]
    v_mov_b32 v212, 0
    v_mov_b32 v216, 0
    v_mov_b32 v220, v204
    v_permlane32_swap_b32 v208, v212
    s_nop 0
    v_permlane32_swap_b32 v216, v220
    v_mov_b32 v209, v205
    v_mov_b32 v213, 0
    v_mov_b32 v217, 0
    v_mov_b32 v221, v205
    v_permlane32_swap_b32 v209, v213
    s_nop 0
    v_permlane32_swap_b32 v217, v221
    v_mov_b32 v210, v206
    v_mov_b32 v214, 0
    v_mov_b32 v218, 0
    v_mov_b32 v222, v206
    v_permlane32_swap_b32 v210, v214
    s_nop 0
    v_permlane32_swap_b32 v218, v222
    v_mov_b32 v10, v254
    v_xor_b32 v11, 64, v254
    v_add_u32 v12, 0x10000, v10
    v_add_u32 v13, 0x10000, v11
    v_lshlrev_b32 v8, 4, v0
    v_add_u32 v9, 114688, v8
    v_cvt_pk_bf16_f32 v200, v196, v196
    v_and_b32 v199, 0xffff0000, v200
    v_sub_f32 v199, v196, v199
    v_cvt_pk_bf16_f32 v199, v199, v199
    v_and_b32 v199, 0xffff, v199
    v_lshl_or_b32 v201, v250, 16, v199
    v_mfma_f32_32x32x16_bf16 v[144:159], v[64:67], v[76:79], v[144:159]
    s_waitcnt lgkmcnt(0)
    v_cmp_gt_u32 vcc, 15, v249
    s_cbranch_vccnz CF_34
CFB_35:
    s_mul_i32 s11, s85, 57344
    s_add_u32 s11, s11, 14336
    s_add_u32 m0, s74, 8192
    s_nop 0
    buffer_load_dwordx4 v252, s[64:67], s11 offen lds
    buffer_load_dwordx4 v253, s[64:67], s11 offen offset:1024 lds
    v_mfma_f32_32x32x16_bf16 v[128:143], v[200:203], v[208:211], v[128:143]
    s_mul_i32 s11, s86, 57344
    s_add_u32 m0, s74, 81920
    s_nop 0
    buffer_load_dwordx4 v252, s[64:67], s11 offen lds
    buffer_load_dwordx4 v253, s[64:67], s11 offen offset:1024 lds
    v_mfma_f32_32x32x16_bf16 v[160:175], v[68:71], v[72:75], v[160:175]
    s_mul_i32 s11, s86, 57344
    s_add_u32 s11, s11, 14336
    s_add_u32 m0, s74, 90112
    s_nop 0
    buffer_load_dwordx4 v252, s[64:67], s11 offen lds
    buffer_load_dwordx4 v253, s[64:67], s11 offen offset:1024 lds
    v_mfma_f32_32x32x16_bf16 v[144:159], v[200:203], v[212:215], v[144:159]
    v_mfma_f32_32x32x16_bf16 v[176:191], v[68:71], v[76:79], v[176:191]
    v_mfma_f32_32x32x16_bf16 v[160:175], v[200:203], v[216:219], v[160:175]
    v_mfma_f32_32x32x16_bf16 v[176:191], v[200:203], v[220:223], v[176:191]
    s_lshl_b32 s12, s70, 1
    s_add_u32 s12, s12, s68
    s_lshl_b32 s12, s12, 5
    s_lshl_b32 s13, s71, 1
    s_add_u32 s12, s12, s13
    s_add_u32 s12, s12, s77
    s_lshl_b32 s12, s12, 3
    s_add_u32 s12, s12, 11014144
    v_mov_b32 v2, s12
    v_mov_b32 v3, s47
    s_lshl_b32 s12, s72, 5
    s_mul_i32 s13, s3, 7
    s_add_u32 s12, s12, s13
    s_lshl_b32 s12, s12, 3
    s_add_u32 s12, s12, 11014144
    v_min_u32 v1, 13, v0
    v_lshl_add_u32 v1, v1, 2, s12
    v_mul_f32 v232, v128, v128
    v_mul_f32 v233, v129, v129
    v_mul_f32 v236, v130, v130
    v_mul_f32 v237, v131, v131
    v_fma_f32 v232, v232, v224, v229
    v_fma_f32 v233, v233, v224, v229
    v_fma_f32 v236, v236, v224, v229
    v_fma_f32 v237, v237, v224, v229
    v_mul_f32_e64 v232, -v232, v128
    v_mul_f32_e64 v233, -v233, v129
    v_mul_f32_e64 v236, -v236, v130
    v_mul_f32_e64 v237, -v237, v131
    v_exp_f32 v232, v232
    s_waitcnt vmcnt(30)
    ds_read_b64_tr_b16 v[16:17], v12 offset:32768
    v_exp_f32 v233, v233
    ds_read_b64_tr_b16 v[18:19], v12 offset:33792
    v_exp_f32 v236, v236
    ds_read_b64_tr_b16 v[20:21], v13 offset:32768
    v_exp_f32 v237, v237
    ds_read_b64_tr_b16 v[22:23], v13 offset:33792
    v_fma_f32 v232, v232, v228, v228
    v_fma_f32 v233, v233, v228, v228
    v_fma_f32 v236, v236, v228, v228
    v_fma_f32 v237, v237, v228, v228
    v_rcp_f32 v232, v232
    s_waitcnt vmcnt(28)
    ds_read_b64_tr_b16 v[24:25], v12 offset:40960
    v_rcp_f32 v233, v233
    ds_read_b64_tr_b16 v[26:27], v12 offset:41984
    v_rcp_f32 v236, v236
    ds_read_b64_tr_b16 v[28:29], v13 offset:40960
    v_rcp_f32 v237, v237
    ds_read_b64_tr_b16 v[30:31], v13 offset:41984
    v_mul_f32 v232, v128, v232
    v_mul_f32 v233, v129, v233
    v_mul_f32 v236, v130, v236
    v_mul_f32 v237, v131, v237
    v_cvt_pk_bf16_f32 v240, v232, v233
    v_cvt_pk_bf16_f32 v241, v236, v237
    v_mul_f32 v232, v132, v132
    v_mul_f32 v233, v133, v133
    v_mul_f32 v236, v134, v134
    v_mul_f32 v237, v135, v135
    v_fma_f32 v232, v232, v224, v229
    v_fma_f32 v233, v233, v224, v229
    v_fma_f32 v236, v236, v224, v229
    v_fma_f32 v237, v237, v224, v229
    v_mul_f32_e64 v232, -v232, v132
    v_mul_f32_e64 v233, -v233, v133
    v_mul_f32_e64 v236, -v236, v134
    v_mul_f32_e64 v237, -v237, v135
    v_exp_f32 v232, v232
    s_waitcnt vmcnt(24)
    ds_read_b64_tr_b16 v[32:33], v10 offset:16384
    v_exp_f32 v233, v233
    ds_read_b64_tr_b16 v[34:35], v10 offset:17408
    v_exp_f32 v236, v236
    s_waitcnt lgkmcnt(6)
    s_mul_i32 s11, s80, 57344
    s_add_u32 s11, s11, 28672
    s_add_u32 m0, s74, 98304
    s_nop 0
    buffer_load_dwordx4 v252, s[64:67], s11 offen lds
    v_exp_f32 v237, v237
    v_fma_f32 v232, v232, v228, v228
    v_fma_f32 v233, v233, v228, v228
    v_fma_f32 v236, v236, v228, v228
    v_fma_f32 v237, v237, v228, v228
    v_rcp_f32 v232, v232
    ds_read_b64_tr_b16 v[36:37], v11 offset:16384
    v_rcp_f32 v233, v233
    ds_read_b64_tr_b16 v[38:39], v11 offset:17408
    v_rcp_f32 v236, v236
    v_rcp_f32 v237, v237
    buffer_load_dwordx4 v253, s[64:67], s11 offen offset:1024 lds
    v_mul_f32 v232, v132, v232
    v_mul_f32 v233, v133, v233
    v_mul_f32 v236, v134, v236
    v_mul_f32 v237, v135, v237
    v_cvt_pk_bf16_f32 v242, v232, v233
    v_cvt_pk_bf16_f32 v243, v236, v237
    v_mul_f32 v232, v136, v136
    v_mul_f32 v233, v137, v137
    v_mul_f32 v236, v138, v138
    v_mul_f32 v237, v139, v139
    v_fma_f32 v232, v232, v224, v229
    v_fma_f32 v233, v233, v224, v229
    v_fma_f32 v236, v236, v224, v229
    v_fma_f32 v237, v237, v224, v229
    v_mul_f32_e64 v232, -v232, v136
    v_mul_f32_e64 v233, -v233, v137
    v_mul_f32_e64 v236, -v236, v138
    v_mul_f32_e64 v237, -v237, v139
    v_exp_f32 v232, v232
    v_exp_f32 v233, v233
    s_waitcnt vmcnt(24)
    ds_read_b64_tr_b16 v[40:41], v10 offset:49152
    v_exp_f32 v236, v236
    ds_read_b64_tr_b16 v[42:43], v10 offset:50176
    v_exp_f32 v237, v237
    s_waitcnt lgkmcnt(6)
    s_mul_i32 s11, s80, 57344
    s_add_u32 s11, s11, 43008
    s_add_u32 m0, s74, 106496
    s_nop 0
    buffer_load_dwordx4 v252, s[64:67], s11 offen lds
    v_fma_f32 v232, v232, v228, v228
    v_fma_f32 v233, v233, v228, v228
    v_fma_f32 v236, v236, v228, v228
    v_fma_f32 v237, v237, v228, v228
    v_rcp_f32 v232, v232
    v_rcp_f32 v233, v233
    ds_read_b64_tr_b16 v[44:45], v11 offset:49152
    v_rcp_f32 v236, v236
    ds_read_b64_tr_b16 v[46:47], v11 offset:50176
    v_rcp_f32 v237, v237
    v_mul_f32 v232, v136, v232
    v_mul_f32 v233, v137, v233
    v_mul_f32 v236, v138, v236
    v_mul_f32 v237, v139, v237
    v_cvt_pk_bf16_f32 v244, v232, v233
    v_cvt_pk_bf16_f32 v245, v236, v237
    v_mul_f32 v232, v140, v140
    v_mul_f32 v233, v141, v141
    v_mul_f32 v236, v142, v142
    v_mul_f32 v237, v143, v143
    v_fma_f32 v232, v232, v224, v229
    v_fma_f32 v233, v233, v224, v229
    v_fma_f32 v236, v236, v224, v229
    v_fma_f32 v237, v237, v224, v229
    v_mul_f32_e64 v232, -v232, v140
    v_mul_f32_e64 v233, -v233, v141
    v_mul_f32_e64 v236, -v236, v142
    v_mul_f32_e64 v237, -v237, v143
    v_exp_f32 v232, v232
    buffer_load_dwordx4 v253, s[64:67], s11 offen offset:1024 lds
    v_exp_f32 v233, v233
    v_exp_f32 v236, v236
    s_waitcnt vmcnt(24)
    ds_read_b64_tr_b16 v[48:49], v10 offset:57344
    v_exp_f32 v237, v237
    ds_read_b64_tr_b16 v[50:51], v10 offset:58368
    v_fma_f32 v232, v232, v228, v228
    v_fma_f32 v233, v233, v228, v228
    v_fma_f32 v236, v236, v228, v228
    v_fma_f32 v237, v237, v228, v228
    v_rcp_f32 v232, v232
    s_waitcnt lgkmcnt(6)
    s_mul_i32 s11, s81, 57344
    s_add_u32 s11, s11, 28672
    s_add_u32 m0, s74, 16384
    s_nop 0
    buffer_load_dwordx4 v252, s[64:67], s11 offen lds
    v_rcp_f32 v233, v233
    v_rcp_f32 v236, v236
    ds_read_b64_tr_b16 v[52:53], v11 offset:57344
    v_rcp_f32 v237, v237
    ds_read_b64_tr_b16 v[54:55], v11 offset:58368
    v_mul_f32 v232, v140, v232
    v_mul_f32 v233, v141, v233
    v_mul_f32 v236, v142, v236
    v_mul_f32 v237, v143, v237
    v_cvt_pk_bf16_f32 v246, v232, v233
    v_cvt_pk_bf16_f32 v247, v236, v237
    s_add_u32 s10, s76, 0
    s_cmp_eq_u32 s14, 0
    s_cbranch_scc1 HS_36
    buffer_store_dwordx4 v[240:243], v8, s[56:59], s10 offen sc1
    buffer_store_dwordx4 v[244:247], v8, s[56:59], s10 offen offset:1024 sc1
HSB_37:
    v_mul_f32 v232, v144, v144
    v_mul_f32 v233, v145, v145
    v_mul_f32 v236, v146, v146
    v_mul_f32 v237, v147, v147
    v_fma_f32 v232, v232, v226, v231
    v_fma_f32 v233, v233, v226, v231
    v_fma_f32 v236, v236, v226, v231
    v_fma_f32 v237, v237, v226, v231
    v_mul_f32_e64 v232, -v232, v144
    v_mul_f32_e64 v233, -v233, v145
    v_mul_f32_e64 v236, -v236, v146
    v_mul_f32_e64 v237, -v237, v147
    v_exp_f32 v232, v232
    v_exp_f32 v233, v233
    buffer_load_dwordx4 v253, s[64:67], s11 offen offset:1024 lds
    v_exp_f32 v236, v236
    v_exp_f32 v237, v237
    s_waitcnt vmcnt(26)
    ds_read_b64_tr_b16 v[56:57], v10 offset:24576
    v_fma_f32 v232, v232, v230, v230
    v_fma_f32 v233, v233, v230, v230
    v_fma_f32 v236, v236, v230, v230
    v_fma_f32 v237, v237, v230, v230
    v_rcp_f32 v232, v232
    ds_read_b64_tr_b16 v[58:59], v10 offset:25600
    v_rcp_f32 v233, v233
    s_waitcnt lgkmcnt(6)
    s_mul_i32 s11, s81, 57344
    s_add_u32 s11, s11, 43008
    s_add_u32 m0, s74, 49152
    s_nop 0
    buffer_load_dwordx4 v252, s[64:67], s11 offen lds
    v_rcp_f32 v236, v236
    v_rcp_f32 v237, v237
    ds_read_b64_tr_b16 v[60:61], v11 offset:24576
    v_mul_f32 v232, v144, v232
    v_mul_f32 v233, v145, v233
    v_mul_f32 v236, v146, v236
    v_mul_f32 v237, v147, v237
    v_cvt_pk_bf16_f32 v192, v232, v233
    v_cvt_pk_bf16_f32 v193, v236, v237
    v_mul_f32 v232, v148, v148
    v_mul_f32 v233, v149, v149
    v_mul_f32 v236, v150, v150
    v_mul_f32 v237, v151, v151
    v_fma_f32 v232, v232, v226, v231
    v_fma_f32 v233, v233, v226, v231
    v_fma_f32 v236, v236, v226, v231
    v_fma_f32 v237, v237, v226, v231
    v_mul_f32_e64 v232, -v232, v148
    v_mul_f32_e64 v233, -v233, v149
    v_mul_f32_e64 v236, -v236, v150
    v_mul_f32_e64 v237, -v237, v151
    v_exp_f32 v232, v232
    ds_read_b64_tr_b16 v[62:63], v11 offset:25600
    v_exp_f32 v233, v233
    v_exp_f32 v236, v236
    buffer_load_dwordx4 v253, s[64:67], s11 offen offset:1024 lds
    v_exp_f32 v237, v237
    v_fma_f32 v232, v232, v230, v230
    v_fma_f32 v233, v233, v230, v230
    v_fma_f32 v236, v236, v230, v230
    v_fma_f32 v237, v237, v230, v230
    v_rcp_f32 v232, v232
    s_waitcnt vmcnt(24)
    ds_read_b64_tr_b16 v[64:65], v10 offset:32768
    v_rcp_f32 v233, v233
    ds_read_b64_tr_b16 v[66:67], v10 offset:33792
    v_rcp_f32 v236, v236
    s_waitcnt lgkmcnt(6)
    s_mul_i32 s11, s82, 57344
    s_add_u32 s11, s11, 28672
    s_add_u32 m0, s74, 57344
    s_nop 0
    buffer_load_dwordx4 v252, s[64:67], s11 offen lds
    v_rcp_f32 v237, v237
    v_mul_f32 v232, v148, v232
    v_mul_f32 v233, v149, v233
    v_mul_f32 v236, v150, v236
    v_mul_f32 v237, v151, v237
    v_cvt_pk_bf16_f32 v194, v232, v233
    v_cvt_pk_bf16_f32 v195, v236, v237
    v_mul_f32 v232, v152, v152
    v_mul_f32 v233, v153, v153
    v_mul_f32 v236, v154, v154
    v_mul_f32 v237, v155, v155
    v_fma_f32 v232, v232, v226, v231
    v_fma_f32 v233, v233, v226, v231
    v_fma_f32 v236, v236, v226, v231
    v_fma_f32 v237, v237, v226, v231
    v_mul_f32_e64 v232, -v232, v152
    v_mul_f32_e64 v233, -v233, v153
    v_mul_f32_e64 v236, -v236, v154
    v_mul_f32_e64 v237, -v237, v155
    v_exp_f32 v232, v232
    ds_read_b64_tr_b16 v[68:69], v11 offset:32768
    v_exp_f32 v233, v233
    ds_read_b64_tr_b16 v[70:71], v11 offset:33792
    v_exp_f32 v236, v236
    v_exp_f32 v237, v237
    buffer_load_dwordx4 v253, s[64:67], s11 offen offset:1024 lds
    v_fma_f32 v232, v232, v230, v230
    v_fma_f32 v233, v233, v230, v230
    v_fma_f32 v236, v236, v230, v230
    v_fma_f32 v237, v237, v230, v230
    v_rcp_f32 v232, v232
    v_rcp_f32 v233, v233
    s_waitcnt vmcnt(24)
    ds_read_b64_tr_b16 v[72:73], v10 offset:40960
    v_rcp_f32 v236, v236
    ds_read_b64_tr_b16 v[74:75], v10 offset:41984
    v_rcp_f32 v237, v237
    s_waitcnt lgkmcnt(6)
    s_mul_i32 s11, s82, 57344
    s_add_u32 s11, s11, 43008
    s_add_u32 m0, s74, 24576
    s_nop 0
    buffer_load_dwordx4 v252, s[64:67], s11 offen lds
    v_mul_f32 v232, v152, v232
    v_mul_f32 v233, v153, v233
    v_mul_f32 v236, v154, v236
    v_mul_f32 v237, v155, v237
    v_cvt_pk_bf16_f32 v196, v232, v233
    v_cvt_pk_bf16_f32 v197, v236, v237
    v_mul_f32 v232, v156, v156
    v_mul_f32 v233, v157, v157
    v_mul_f32 v236, v158, v158
    v_mul_f32 v237, v159, v159
    v_fma_f32 v232, v232, v226, v231
    v_fma_f32 v233, v233, v226, v231
    v_fma_f32 v236, v236, v226, v231
    v_fma_f32 v237, v237, v226, v231
    v_mul_f32_e64 v232, -v232, v156
    v_mul_f32_e64 v233, -v233, v157
    v_mul_f32_e64 v236, -v236, v158
    v_mul_f32_e64 v237, -v237, v159
    v_exp_f32 v232, v232
    v_exp_f32 v233, v233
    ds_read_b64_tr_b16 v[76:77], v11 offset:40960
    v_exp_f32 v236, v236
    ds_read_b64_tr_b16 v[78:79], v11 offset:41984
    v_exp_f32 v237, v237
    v_fma_f32 v232, v232, v230, v230
    v_fma_f32 v233, v233, v230, v230
    v_fma_f32 v236, v236, v230, v230
    v_fma_f32 v237, v237, v230, v230
    v_rcp_f32 v232, v232
    buffer_load_dwordx4 v253, s[64:67], s11 offen offset:1024 lds
    v_rcp_f32 v233, v233
    v_rcp_f32 v236, v236
    s_waitcnt vmcnt(24)
    ds_read_b64_tr_b16 v[80:81], v12 offset:0
    v_rcp_f32 v237, v237
    ds_read_b64_tr_b16 v[82:83], v12 offset:1024
    v_mul_f32 v232, v156, v232
    v_mul_f32 v233, v157, v233
    v_mul_f32 v236, v158, v236
    v_mul_f32 v237, v159, v237
    v_cvt_pk_bf16_f32 v198, v232, v233
    v_cvt_pk_bf16_f32 v199, v236, v237
    s_add_u32 s10, s76, 114688
    s_cmp_eq_u32 s14, 0
    s_cbranch_scc1 HS_38
    buffer_store_dwordx4 v[192:195], v8, s[56:59], s10 offen sc1
    buffer_store_dwordx4 v[196:199], v8, s[56:59], s10 offen offset:1024 sc1
HSB_39:
    v_mul_f32 v232, v160, v160
    v_mul_f32 v233, v161, v161
    v_mul_f32 v236, v162, v162
    v_mul_f32 v237, v163, v163
    v_fma_f32 v232, v232, v224, v229
    v_fma_f32 v233, v233, v224, v229
    v_fma_f32 v236, v236, v224, v229
    v_fma_f32 v237, v237, v224, v229
    v_mul_f32_e64 v232, -v232, v160
    v_mul_f32_e64 v233, -v233, v161
    v_mul_f32_e64 v236, -v236, v162
    v_mul_f32_e64 v237, -v237, v163
    v_exp_f32 v232, v232
    s_waitcnt lgkmcnt(6)
    s_mul_i32 s11, s83, 57344
    s_add_u32 s11, s11, 28672
    s_add_u32 m0, s74, 32768
    s_nop 0
    buffer_load_dwordx4 v252, s[64:67], s11 offen lds
    v_exp_f32 v233, v233
    v_exp_f32 v236, v236
    ds_read_b64_tr_b16 v[84:85], v13 offset:0
    v_exp_f32 v237, v237
    ds_read_b64_tr_b16 v[86:87], v13 offset:1024
    v_fma_f32 v232, v232, v228, v228
    v_fma_f32 v233, v233, v228, v228
    v_fma_f32 v236, v236, v228, v228
    v_fma_f32 v237, v237, v228, v228
    v_rcp_f32 v232, v232
    v_rcp_f32 v233, v233
    buffer_load_dwordx4 v253, s[64:67], s11 offen offset:1024 lds
    v_rcp_f32 v236, v236
    v_rcp_f32 v237, v237
    s_waitcnt vmcnt(26)
    ds_read_b64_tr_b16 v[88:89], v12 offset:8192
    v_mul_f32 v232, v160, v232
    v_mul_f32 v233, v161, v233
    v_mul_f32 v236, v162, v236
    v_mul_f32 v237, v163, v237
    v_cvt_pk_bf16_f32 v240, v232, v233
    v_cvt_pk_bf16_f32 v241, v236, v237
    v_mul_f32 v232, v164, v164
    v_mul_f32 v233, v165, v165
    v_mul_f32 v236, v166, v166
    v_mul_f32 v237, v167, v167
    v_fma_f32 v232, v232, v224, v229
    v_fma_f32 v233, v233, v224, v229
    v_fma_f32 v236, v236, v224, v229
    v_fma_f32 v237, v237, v224, v229
    v_mul_f32_e64 v232, -v232, v164
    v_mul_f32_e64 v233, -v233, v165
    v_mul_f32_e64 v236, -v236, v166
    v_mul_f32_e64 v237, -v237, v167
    v_exp_f32 v232, v232
    ds_read_b64_tr_b16 v[90:91], v12 offset:9216
    v_exp_f32 v233, v233
    s_waitcnt lgkmcnt(6)
    s_mul_i32 s11, s83, 57344
    s_add_u32 s11, s11, 43008
    s_add_u32 m0, s74, 40960
    s_nop 0
    buffer_load_dwordx4 v252, s[64:67], s11 offen lds
    v_exp_f32 v236, v236
    v_exp_f32 v237, v237
    ds_read_b64_tr_b16 v[92:93], v13 offset:8192
    v_fma_f32 v232, v232, v228, v228
    v_fma_f32 v233, v233, v228, v228
    v_fma_f32 v236, v236, v228, v228
    v_fma_f32 v237, v237, v228, v228
    v_rcp_f32 v232, v232
    ds_read_b64_tr_b16 v[94:95], v13 offset:9216
    v_rcp_f32 v233, v233
    v_rcp_f32 v236, v236
    buffer_load_dwordx4 v253, s[64:67], s11 offen offset:1024 lds
    v_rcp_f32 v237, v237
    v_mul_f32 v232, v164, v232
    v_mul_f32 v233, v165, v233
    v_mul_f32 v236, v166, v236
    v_mul_f32 v237, v167, v237
    v_cvt_pk_bf16_f32 v242, v232, v233
    v_cvt_pk_bf16_f32 v243, v236, v237
    v_mul_f32 v232, v168, v168
    v_mul_f32 v233, v169, v169
    v_mul_f32 v236, v170, v170
    v_mul_f32 v237, v171, v171
    v_fma_f32 v232, v232, v224, v229
    v_fma_f32 v233, v233, v224, v229
    v_fma_f32 v236, v236, v224, v229
    v_fma_f32 v237, v237, v224, v229
    v_mul_f32_e64 v232, -v232, v168
    v_mul_f32_e64 v233, -v233, v169
    v_mul_f32_e64 v236, -v236, v170
    v_mul_f32_e64 v237, -v237, v171
    v_exp_f32 v232, v232
    s_waitcnt vmcnt(26)
    ds_read_b64_tr_b16 v[96:97], v10 offset:0
    v_exp_f32 v233, v233
    ds_read_b64_tr_b16 v[98:99], v10 offset:1024
    v_exp_f32 v236, v236
    s_waitcnt lgkmcnt(6)
    s_mul_i32 s11, s84, 57344
    s_add_u32 s11, s11, 28672
    s_add_u32 m0, s74, 65536
    s_nop 0
    buffer_load_dwordx4 v252, s[64:67], s11 offen lds
    v_exp_f32 v237, v237
    v_fma_f32 v232, v232, v228, v228
    v_fma_f32 v233, v233, v228, v228
    v_fma_f32 v236, v236, v228, v228
    v_fma_f32 v237, v237, v228, v228
    v_rcp_f32 v232, v232
    ds_read_b64_tr_b16 v[100:101], v11 offset:0
    v_rcp_f32 v233, v233
    ds_read_b64_tr_b16 v[102:103], v11 offset:1024
    v_rcp_f32 v236, v236
    v_rcp_f32 v237, v237
    buffer_load_dwordx4 v253, s[64:67], s11 offen offset:1024 lds
    v_mul_f32 v232, v168, v232
    v_mul_f32 v233, v169, v233
    v_mul_f32 v236, v170, v236
    v_mul_f32 v237, v171, v237
    v_cvt_pk_bf16_f32 v244, v232, v233
    v_cvt_pk_bf16_f32 v245, v236, v237
    s_waitcnt vmcnt(6)
    s_mov_b64 exec, 1
    s_cmp_eq_u32 s14, 0
    s_cbranch_scc1 FS_40
    global_store_dword v2, v3, s[44:45] offset:0
FSB_41:
    s_mov_b64 exec, -1
    v_mul_f32 v232, v172, v172
    v_mul_f32 v233, v173, v173
    v_mul_f32 v236, v174, v174
    v_mul_f32 v237, v175, v175
    v_fma_f32 v232, v232, v224, v229
    v_fma_f32 v233, v233, v224, v229
    v_fma_f32 v236, v236, v224, v229
    v_fma_f32 v237, v237, v224, v229
    v_mul_f32_e64 v232, -v232, v172
    v_mul_f32_e64 v233, -v233, v173
    v_mul_f32_e64 v236, -v236, v174
    v_mul_f32_e64 v237, -v237, v175
    v_exp_f32 v232, v232
    v_exp_f32 v233, v233
    s_waitcnt vmcnt(27)
    ds_read_b64_tr_b16 v[104:105], v10 offset:8192
    v_exp_f32 v236, v236
    ds_read_b64_tr_b16 v[106:107], v10 offset:9216
    v_exp_f32 v237, v237
    s_waitcnt lgkmcnt(6)
    s_mul_i32 s11, s84, 57344
    s_add_u32 s11, s11, 43008
    s_add_u32 m0, s74, 73728
    s_nop 0
    buffer_load_dwordx4 v252, s[64:67], s11 offen lds
    v_fma_f32 v232, v232, v228, v228
    v_fma_f32 v233, v233, v228, v228
    v_fma_f32 v236, v236, v228, v228
    v_fma_f32 v237, v237, v228, v228
    v_rcp_f32 v232, v232
    v_rcp_f32 v233, v233
    ds_read_b64_tr_b16 v[108:109], v11 offset:8192
    v_rcp_f32 v236, v236
    ds_read_b64_tr_b16 v[110:111], v11 offset:9216
    v_rcp_f32 v237, v237
    v_mul_f32 v232, v172, v232
    v_mul_f32 v233, v173, v233
    v_mul_f32 v236, v174, v236
    v_mul_f32 v237, v175, v237
    v_cvt_pk_bf16_f32 v246, v232, v233
    v_cvt_pk_bf16_f32 v247, v236, v237
    s_add_u32 s10, s76, 2048
    s_cmp_eq_u32 s14, 0
    s_cbranch_scc1 HS_42
    buffer_store_dwordx4 v[240:243], v8, s[56:59], s10 offen sc1
    buffer_store_dwordx4 v[244:247], v8, s[56:59], s10 offen offset:1024 sc1
HSB_43:
    v_mul_f32 v232, v176, v176
    v_mul_f32 v233, v177, v177
    v_mul_f32 v236, v178, v178
    v_mul_f32 v237, v179, v179
    v_fma_f32 v232, v232, v226, v231
    v_fma_f32 v233, v233, v226, v231
    v_fma_f32 v236, v236, v226, v231
    v_fma_f32 v237, v237, v226, v231
    v_mul_f32_e64 v232, -v232, v176
    v_mul_f32_e64 v233, -v233, v177
    v_mul_f32_e64 v236, -v236, v178
    v_mul_f32_e64 v237, -v237, v179
    v_exp_f32 v232, v232
    buffer_load_dwordx4 v253, s[64:67], s11 offen offset:1024 lds
    v_exp_f32 v233, v233
    v_exp_f32 v236, v236
    s_waitcnt vmcnt(29)
    ds_read_b64_tr_b16 v[112:113], v12 offset:16384
    v_exp_f32 v237, v237
    ds_read_b64_tr_b16 v[114:115], v12 offset:17408
    v_fma_f32 v232, v232, v230, v230
    v_fma_f32 v233, v233, v230, v230
    v_fma_f32 v236, v236, v230, v230
    v_fma_f32 v237, v237, v230, v230
    v_rcp_f32 v232, v232
    s_waitcnt lgkmcnt(6)
    s_mul_i32 s11, s85, 57344
    s_add_u32 s11, s11, 28672
    s_add_u32 m0, s74, 0
    s_nop 0
    buffer_load_dwordx4 v252, s[64:67], s11 offen lds
    v_rcp_f32 v233, v233
    v_rcp_f32 v236, v236
    ds_read_b64_tr_b16 v[116:117], v13 offset:16384
    v_rcp_f32 v237, v237
    ds_read_b64_tr_b16 v[118:119], v13 offset:17408
    v_mul_f32 v232, v176, v232
    v_mul_f32 v233, v177, v233
    v_mul_f32 v236, v178, v236
    v_mul_f32 v237, v179, v237
    v_cvt_pk_bf16_f32 v192, v232, v233
    v_cvt_pk_bf16_f32 v193, v236, v237
    v_mul_f32 v232, v180, v180
    v_mul_f32 v233, v181, v181
    v_mul_f32 v236, v182, v182
    v_mul_f32 v237, v183, v183
    v_fma_f32 v232, v232, v226, v231
    v_fma_f32 v233, v233, v226, v231
    v_fma_f32 v236, v236, v226, v231
    v_fma_f32 v237, v237, v226, v231
    v_mul_f32_e64 v232, -v232, v180
    v_mul_f32_e64 v233, -v233, v181
    v_mul_f32_e64 v236, -v236, v182
    v_mul_f32_e64 v237, -v237, v183
    v_exp_f32 v232, v232
    v_exp_f32 v233, v233
    buffer_load_dwordx4 v253, s[64:67], s11 offen offset:1024 lds
    v_exp_f32 v236, v236
    v_exp_f32 v237, v237
    s_waitcnt vmcnt(29)
    ds_read_b64_tr_b16 v[120:121], v12 offset:24576
    v_fma_f32 v232, v232, v230, v230
    v_fma_f32 v233, v233, v230, v230
    v_fma_f32 v236, v236, v230, v230
    v_fma_f32 v237, v237, v230, v230
    v_rcp_f32 v232, v232
    ds_read_b64_tr_b16 v[122:123], v12 offset:25600
    v_rcp_f32 v233, v233
    s_waitcnt lgkmcnt(6)
    s_mul_i32 s11, s85, 57344
    s_add_u32 s11, s11, 43008
    s_add_u32 m0, s74, 8192
    s_nop 0
    buffer_load_dwordx4 v252, s[64:67], s11 offen lds
    v_rcp_f32 v236, v236
    v_rcp_f32 v237, v237
    ds_read_b64_tr_b16 v[124:125], v13 offset:24576
    v_mul_f32 v232, v180, v232
    v_mul_f32 v233, v181, v233
    v_mul_f32 v236, v182, v236
    v_mul_f32 v237, v183, v237
    v_cvt_pk_bf16_f32 v194, v232, v233
    v_cvt_pk_bf16_f32 v195, v236, v237
    global_load_dword v200, v1, s[44:45] sc1
    v_mul_f32 v232, v184, v184
    v_mul_f32 v233, v185, v185
    v_mul_f32 v236, v186, v186
    v_mul_f32 v237, v187, v187
    v_fma_f32 v232, v232, v226, v231
    v_fma_f32 v233, v233, v226, v231
    v_fma_f32 v236, v236, v226, v231
    v_fma_f32 v237, v237, v226, v231
    v_mul_f32_e64 v232, -v232, v184
    v_mul_f32_e64 v233, -v233, v185
    v_mul_f32_e64 v236, -v236, v186
    v_mul_f32_e64 v237, -v237, v187
    v_exp_f32 v232, v232
    ds_read_b64_tr_b16 v[126:127], v13 offset:25600
    v_exp_f32 v233, v233
    v_exp_f32 v236, v236
    buffer_load_dwordx4 v253, s[64:67], s11 offen offset:1024 lds
    v_exp_f32 v237, v237
    v_fma_f32 v232, v232, v230, v230
    v_fma_f32 v233, v233, v230, v230
    v_fma_f32 v236, v236, v230, v230
    v_fma_f32 v237, v237, v230, v230
    v_rcp_f32 v232, v232
    v_rcp_f32 v233, v233
    v_rcp_f32 v236, v236
    s_waitcnt lgkmcnt(4)
    s_mul_i32 s11, s86, 57344
    s_add_u32 s11, s11, 28672
    s_add_u32 m0, s74, 81920
    s_nop 0
    buffer_load_dwordx4 v252, s[64:67], s11 offen lds
    v_rcp_f32 v237, v237
    v_mul_f32 v232, v184, v232
    v_mul_f32 v233, v185, v233
    v_mul_f32 v236, v186, v236
    v_mul_f32 v237, v187, v237
    v_cvt_pk_bf16_f32 v196, v232, v233
    v_cvt_pk_bf16_f32 v197, v236, v237
    v_mul_f32 v232, v188, v188
    v_mul_f32 v233, v189, v189
    v_mul_f32 v236, v190, v190
    v_mul_f32 v237, v191, v191
    v_fma_f32 v232, v232, v226, v231
    v_fma_f32 v233, v233, v226, v231
    v_fma_f32 v236, v236, v226, v231
    v_fma_f32 v237, v237, v226, v231
    v_mul_f32_e64 v232, -v232, v188
    v_mul_f32_e64 v233, -v233, v189
    v_mul_f32_e64 v236, -v236, v190
    v_mul_f32_e64 v237, -v237, v191
    v_exp_f32 v232, v232
    v_exp_f32 v233, v233
    v_exp_f32 v236, v236
    v_exp_f32 v237, v237
    buffer_load_dwordx4 v253, s[64:67], s11 offen offset:1024 lds
    v_fma_f32 v232, v232, v230, v230
    v_fma_f32 v233, v233, v230, v230
    v_fma_f32 v236, v236, v230, v230
    v_fma_f32 v237, v237, v230, v230
    v_rcp_f32 v232, v232
    v_rcp_f32 v233, v233
    v_rcp_f32 v236, v236
    v_rcp_f32 v237, v237
    s_waitcnt lgkmcnt(0)
    s_mul_i32 s11, s86, 57344
    s_add_u32 s11, s11, 43008
    s_add_u32 m0, s74, 90112
    s_nop 0
    buffer_load_dwordx4 v252, s[64:67], s11 offen lds
    v_mul_f32 v232, v188, v232
    v_mul_f32 v233, v189, v233
    v_mul_f32 v236, v190, v236
    v_mul_f32 v237, v191, v237
    v_cvt_pk_bf16_f32 v198, v232, v233
    v_cvt_pk_bf16_f32 v199, v236, v237
    s_add_u32 s10, s76, 116736
    s_cmp_eq_u32 s14, 0
    s_cbranch_scc1 HS_44
    buffer_store_dwordx4 v[192:195], v8, s[56:59], s10 offen sc1
    buffer_store_dwordx4 v[196:199], v8, s[56:59], s10 offen offset:1024 sc1
HSB_45:
    buffer_load_dwordx4 v253, s[64:67], s11 offen offset:1024 lds
    s_waitcnt vmcnt(7)
PAB_47:
    v_cmp_ne_u32 vcc, s47, v200
    s_and_b32 s10, vcc_lo, 0x1555
    s_cbranch_scc1 PA_46
    buffer_load_dwordx4 v[200:203], v8, s[56:59], s87 offen sc1
    buffer_load_dwordx4 v[204:207], v9, s[56:59], s87 offen sc1
    buffer_load_dwordx4 v[208:211], v8, s[56:59], s87 offen offset:1024 sc1
    buffer_load_dwordx4 v[212:215], v9, s[56:59], s87 offen offset:1024 sc1
    buffer_load_dwordx4 v[216:219], v8, s[56:59], s88 offen sc1
    buffer_load_dwordx4 v[220:223], v9, s[56:59], s88 offen sc1
    buffer_load_dwordx4 v[224:227], v8, s[56:59], s88 offen offset:1024 sc1
    buffer_load_dwordx4 v[228:231], v9, s[56:59], s88 offen offset:1024 sc1
    buffer_load_dwordx4 v[232:235], v8, s[56:59], s89 offen sc1
    buffer_load_dwordx4 v[236:239], v9, s[56:59], s89 offen sc1
    buffer_load_dwordx4 v[240:243], v8, s[56:59], s89 offen offset:1024 sc1
    buffer_load_dwordx4 v[244:247], v9, s[56:59], s89 offen offset:1024 sc1
    v_mov_b32 v192, v251
    v_mov_b32 v194, 0
    v_mov_b32 v193, 0
    v_mov_b32 v195, 0
    v_mov_b32 v196, 0x3e80
    v_permlane32_swap_b32 v192, v194
    v_mov_b32 v197, 0
    v_mov_b32 v198, 0
    v_mov_b32 v199, 0
    s_nop 1
    v_mfma_f32_32x32x16_bf16 v[128:143], v[192:195], v[196:199], 0
    v_mfma_f32_32x32x16_bf16 v[144:159], v[192:195], v[196:199], 0
    v_mfma_f32_32x32x16_bf16 v[160:175], v[194:197], v[196:199], 0
    v_mfma_f32_32x32x16_bf16 v[176:191], v[194:197], v[196:199], 0
    buffer_load_dwordx4 v[192:195], v8, s[56:59], s90 offen sc1
    buffer_load_dwordx4 v[196:199], v9, s[56:59], s90 offen sc1
    s_waitcnt vmcnt(15)
    s_mov_b64 exec, 1
    s_cmp_eq_u32 s14, 0
    s_cbranch_scc1 FS_48
    global_store_dword v2, v3, s[44:45] offset:4
FSB_49:
    s_mov_b64 exec, -1
    s_waitcnt vmcnt(13)
    s_waitcnt lgkmcnt(0)
    v_mfma_f32_32x32x16_bf16 v[128:143], v[16:19], v[200:203], v[128:143]
    v_mfma_f32_32x32x16_bf16 v[144:159], v[16:19], v[204:207], v[144:159]
    v_mfma_f32_32x32x16_bf16 v[160:175], v[20:23], v[200:203], v[160:175]
    v_mfma_f32_32x32x16_bf16 v[176:191], v[20:23], v[204:207], v[176:191]
    buffer_load_dwordx4 v[200:203], v8, s[56:59], s90 offen offset:1024 sc1
    buffer_load_dwordx4 v[204:207], v9, s[56:59], s90 offen offset:1024 sc1
    ds_read_b64_tr_b16 v[16:17], v12 offset:32768
    ds_read_b64_tr_b16 v[18:19], v12 offset:33792
    ds_read_b64_tr_b16 v[20:21], v13 offset:32768
    ds_read_b64_tr_b16 v[22:23], v13 offset:33792
    s_waitcnt vmcnt(13)
    v_mfma_f32_32x32x16_bf16 v[128:143], v[24:27], v[208:211], v[128:143]
    v_mfma_f32_32x32x16_bf16 v[144:159], v[24:27], v[212:215], v[144:159]
    v_mfma_f32_32x32x16_bf16 v[160:175], v[28:31], v[208:211], v[160:175]
    v_mfma_f32_32x32x16_bf16 v[176:191], v[28:31], v[212:215], v[176:191]
    buffer_load_dwordx4 v[208:211], v8, s[56:59], s91 offen sc1
    buffer_load_dwordx4 v[212:215], v9, s[56:59], s91 offen sc1
    global_load_dword v2, v1, s[44:45] sc1
    ds_read_b64_tr_b16 v[24:25], v12 offset:40960
    ds_read_b64_tr_b16 v[26:27], v12 offset:41984
    ds_read_b64_tr_b16 v[28:29], v13 offset:40960
    ds_read_b64_tr_b16 v[30:31], v13 offset:41984
    s_waitcnt vmcnt(14)
    v_mfma_f32_32x32x16_bf16 v[128:143], v[32:35], v[216:219], v[128:143]
    v_mfma_f32_32x32x16_bf16 v[144:159], v[32:35], v[220:223], v[144:159]
    v_mfma_f32_32x32x16_bf16 v[160:175], v[36:39], v[216:219], v[160:175]
    v_mfma_f32_32x32x16_bf16 v[176:191], v[36:39], v[220:223], v[176:191]
    buffer_load_dwordx4 v[216:219], v8, s[56:59], s91 offen offset:1024 sc1
    buffer_load_dwordx4 v[220:223], v9, s[56:59], s91 offen offset:1024 sc1
    ds_read_b64_tr_b16 v[32:33], v10 offset:16384
    ds_read_b64_tr_b16 v[34:35], v10 offset:17408
    ds_read_b64_tr_b16 v[36:37], v11 offset:16384
    ds_read_b64_tr_b16 v[38:39], v11 offset:17408
    s_waitcnt vmcnt(14)
    v_mfma_f32_32x32x16_bf16 v[128:143], v[40:43], v[224:227], v[128:143]
    v_mfma_f32_32x32x16_bf16 v[144:159], v[40:43], v[228:231], v[144:159]
    v_mfma_f32_32x32x16_bf16 v[160:175], v[44:47], v[224:227], v[160:175]
    v_mfma_f32_32x32x16_bf16 v[176:191], v[44:47], v[228:231], v[176:191]
    buffer_load_dwordx4 v[224:227], v8, s[56:59], s92 offen sc1
    buffer_load_dwordx4 v[228:231], v9, s[56:59], s92 offen sc1
    ds_read_b64_tr_b16 v[40:41], v10 offset:49152
    ds_read_b64_tr_b16 v[42:43], v10 offset:50176
    ds_read_b64_tr_b16 v[44:45], v11 offset:49152
    ds_read_b64_tr_b16 v[46:47], v11 offset:50176
    s_waitcnt vmcnt(14)
    v_mfma_f32_32x32x16_bf16 v[128:143], v[48:51], v[232:235], v[128:143]
    v_mfma_f32_32x32x16_bf16 v[144:159], v[48:51], v[236:239], v[144:159]
    v_mfma_f32_32x32x16_bf16 v[160:175], v[52:55], v[232:235], v[160:175]
    v_mfma_f32_32x32x16_bf16 v[176:191], v[52:55], v[236:239], v[176:191]
    buffer_load_dwordx4 v[232:235], v8, s[56:59], s92 offen offset:1024 sc1
    buffer_load_dwordx4 v[236:239], v9, s[56:59], s92 offen offset:1024 sc1
    ds_read_b64_tr_b16 v[48:49], v10 offset:57344
    ds_read_b64_tr_b16 v[50:51], v10 offset:58368
    ds_read_b64_tr_b16 v[52:53], v11 offset:57344
    ds_read_b64_tr_b16 v[54:55], v11 offset:58368
    s_waitcnt vmcnt(14)
    v_mfma_f32_32x32x16_bf16 v[128:143], v[56:59], v[240:243], v[128:143]
    v_mfma_f32_32x32x16_bf16 v[144:159], v[56:59], v[244:247], v[144:159]
    v_mfma_f32_32x32x16_bf16 v[160:175], v[60:63], v[240:243], v[160:175]
    v_mfma_f32_32x32x16_bf16 v[176:191], v[60:63], v[244:247], v[176:191]
    buffer_load_dwordx4 v[240:243], v8, s[56:59], s93 offen sc1
    buffer_load_dwordx4 v[244:247], v9, s[56:59], s93 offen sc1
    ds_read_b64_tr_b16 v[56:57], v10 offset:24576
    ds_read_b64_tr_b16 v[58:59], v10 offset:25600
    ds_read_b64_tr_b16 v[60:61], v11 offset:24576
    ds_read_b64_tr_b16 v[62:63], v11 offset:25600
    s_waitcnt vmcnt(14)
    v_mfma_f32_32x32x16_bf16 v[128:143], v[64:67], v[192:195], v[128:143]
    v_mfma_f32_32x32x16_bf16 v[144:159], v[64:67], v[196:199], v[144:159]
    v_mfma_f32_32x32x16_bf16 v[160:175], v[68:71], v[192:195], v[160:175]
    v_mfma_f32_32x32x16_bf16 v[176:191], v[68:71], v[196:199], v[176:191]
    buffer_load_dwordx4 v[192:195], v8, s[56:59], s93 offen offset:1024 sc1
    buffer_load_dwordx4 v[196:199], v9, s[56:59], s93 offen offset:1024 sc1
    ds_read_b64_tr_b16 v[64:65], v10 offset:32768
    ds_read_b64_tr_b16 v[66:67], v10 offset:33792
    ds_read_b64_tr_b16 v[68:69], v11 offset:32768
    ds_read_b64_tr_b16 v[70:71], v11 offset:33792
    s_waitcnt vmcnt(13)
    v_mfma_f32_32x32x16_bf16 v[128:143], v[72:75], v[200:203], v[128:143]
    v_mfma_f32_32x32x16_bf16 v[144:159], v[72:75], v[204:207], v[144:159]
    v_mfma_f32_32x32x16_bf16 v[160:175], v[76:79], v[200:203], v[160:175]
    v_mfma_f32_32x32x16_bf16 v[176:191], v[76:79], v[204:207], v[176:191]
    s_waitcnt vmcnt(10)
PBB_51:
    v_cmp_ne_u32 vcc, s47, v2
    s_and_b32 s10, vcc_lo, 0x2aaa
    s_cbranch_scc1 PB_50
    buffer_load_dwordx4 v[200:203], v8, s[56:59], s87 offen offset:2048 sc1
    buffer_load_dwordx4 v[204:207], v9, s[56:59], s87 offen offset:2048 sc1
    ds_read_b64_tr_b16 v[72:73], v10 offset:40960
    ds_read_b64_tr_b16 v[74:75], v10 offset:41984
    ds_read_b64_tr_b16 v[76:77], v11 offset:40960
    ds_read_b64_tr_b16 v[78:79], v11 offset:41984
    s_waitcnt vmcnt(13)
    v_mfma_f32_32x32x16_bf16 v[128:143], v[80:83], v[208:211], v[128:143]
    v_mfma_f32_32x32x16_bf16 v[144:159], v[80:83], v[212:215], v[144:159]
    v_mfma_f32_32x32x16_bf16 v[160:175], v[84:87], v[208:211], v[160:175]
    v_mfma_f32_32x32x16_bf16 v[176:191], v[84:87], v[212:215], v[176:191]
    buffer_load_dwordx4 v[208:211], v8, s[56:59], s87 offen offset:3072 sc1
    buffer_load_dwordx4 v[212:215], v9, s[56:59], s87 offen offset:3072 sc1
    ds_read_b64_tr_b16 v[80:81], v12 offset:0
    ds_read_b64_tr_b16 v[82:83], v12 offset:1024
    ds_read_b64_tr_b16 v[84:85], v13 offset:0
    ds_read_b64_tr_b16 v[86:87], v13 offset:1024
    s_waitcnt vmcnt(12)
    v_mfma_f32_32x32x16_bf16 v[128:143], v[88:91], v[216:219], v[128:143]
    v_mfma_f32_32x32x16_bf16 v[144:159], v[88:91], v[220:223], v[144:159]
    v_mfma_f32_32x32x16_bf16 v[160:175], v[92:95], v[216:219], v[160:175]
    v_mfma_f32_32x32x16_bf16 v[176:191], v[92:95], v[220:223], v[176:191]
    buffer_load_dwordx4 v[216:219], v8, s[56:59], s88 offen offset:2048 sc1
    buffer_load_dwordx4 v[220:223], v9, s[56:59], s88 offen offset:2048 sc1
    ds_read_b64_tr_b16 v[88:89], v12 offset:8192
    ds_read_b64_tr_b16 v[90:91], v12 offset:9216
    ds_read_b64_tr_b16 v[92:93], v13 offset:8192
    ds_read_b64_tr_b16 v[94:95], v13 offset:9216
    s_waitcnt vmcnt(12)
    v_mfma_f32_32x32x16_bf16 v[128:143], v[96:99], v[224:227], v[128:143]
    v_mfma_f32_32x32x16_bf16 v[144:159], v[96:99], v[228:231], v[144:159]
    v_mfma_f32_32x32x16_bf16 v[160:175], v[100:103], v[224:227], v[160:175]
    v_mfma_f32_32x32x16_bf16 v[176:191], v[100:103], v[228:231], v[176:191]
    buffer_load_dwordx4 v[224:227], v8, s[56:59], s88 offen offset:3072 sc1
    buffer_load_dwordx4 v[228:231], v9, s[56:59], s88 offen offset:3072 sc1
    ds_read_b64_tr_b16 v[96:97], v10 offset:0
    ds_read_b64_tr_b16 v[98:99], v10 offset:1024
    ds_read_b64_tr_b16 v[100:101], v11 offset:0
    ds_read_b64_tr_b16 v[102:103], v11 offset:1024
    s_waitcnt vmcnt(12)
    v_mfma_f32_32x32x16_bf16 v[128:143], v[104:107], v[232:235], v[128:143]
    v_mfma_f32_32x32x16_bf16 v[144:159], v[104:107], v[236:239], v[144:159]
    v_mfma_f32_32x32x16_bf16 v[160:175], v[108:111], v[232:235], v[160:175]
    v_mfma_f32_32x32x16_bf16 v[176:191], v[108:111], v[236:239], v[176:191]
    buffer_load_dwordx4 v[232:235], v8, s[56:59], s89 offen offset:2048 sc1
    buffer_load_dwordx4 v[236:239], v9, s[56:59], s89 offen offset:2048 sc1
    ds_read_b64_tr_b16 v[104:105], v10 offset:8192
    ds_read_b64_tr_b16 v[106:107], v10 offset:9216
    ds_read_b64_tr_b16 v[108:109], v11 offset:8192
    ds_read_b64_tr_b16 v[110:111], v11 offset:9216
    s_waitcnt vmcnt(12)
    v_mfma_f32_32x32x16_bf16 v[128:143], v[112:115], v[240:243], v[128:143]
    v_mfma_f32_32x32x16_bf16 v[144:159], v[112:115], v[244:247], v[144:159]
    v_mfma_f32_32x32x16_bf16 v[160:175], v[116:119], v[240:243], v[160:175]
    v_mfma_f32_32x32x16_bf16 v[176:191], v[116:119], v[244:247], v[176:191]
    buffer_load_dwordx4 v[240:243], v8, s[56:59], s89 offen offset:3072 sc1
    buffer_load_dwordx4 v[244:247], v9, s[56:59], s89 offen offset:3072 sc1
    ds_read_b64_tr_b16 v[112:113], v12 offset:16384
    ds_read_b64_tr_b16 v[114:115], v12 offset:17408
    ds_read_b64_tr_b16 v[116:117], v13 offset:16384
    ds_read_b64_tr_b16 v[118:119], v13 offset:17408
    s_waitcnt vmcnt(12)
    v_mfma_f32_32x32x16_bf16 v[128:143], v[120:123], v[192:195], v[128:143]
    v_mfma_f32_32x32x16_bf16 v[144:159], v[120:123], v[196:199], v[144:159]
    v_mfma_f32_32x32x16_bf16 v[160:175], v[124:127], v[192:195], v[160:175]
    v_mfma_f32_32x32x16_bf16 v[176:191], v[124:127], v[196:199], v[176:191]
    buffer_load_dwordx4 v[192:195], v8, s[56:59], s90 offen offset:2048 sc1
    buffer_load_dwordx4 v[196:199], v9, s[56:59], s90 offen offset:2048 sc1
    ds_read_b64_tr_b16 v[120:121], v12 offset:24576
    ds_read_b64_tr_b16 v[122:123], v12 offset:25600
    ds_read_b64_tr_b16 v[124:125], v13 offset:24576
    ds_read_b64_tr_b16 v[126:127], v13 offset:25600
    s_waitcnt vmcnt(12)
    s_waitcnt lgkmcnt(15)
    v_mfma_f32_32x32x16_bf16 v[128:143], v[16:19], v[200:203], v[128:143]
    v_mfma_f32_32x32x16_bf16 v[144:159], v[16:19], v[204:207], v[144:159]
    v_mfma_f32_32x32x16_bf16 v[160:175], v[20:23], v[200:203], v[160:175]
    v_mfma_f32_32x32x16_bf16 v[176:191], v[20:23], v[204:207], v[176:191]
    buffer_load_dwordx4 v[200:203], v8, s[56:59], s90 offen offset:3072 sc1
    buffer_load_dwordx4 v[204:207], v9, s[56:59], s90 offen offset:3072 sc1
    s_waitcnt vmcnt(12)
    s_waitcnt lgkmcnt(15)
    v_mfma_f32_32x32x16_bf16 v[128:143], v[24:27], v[208:211], v[128:143]
    v_mfma_f32_32x32x16_bf16 v[144:159], v[24:27], v[212:215], v[144:159]
    v_mfma_f32_32x32x16_bf16 v[160:175], v[28:31], v[208:211], v[160:175]
    v_mfma_f32_32x32x16_bf16 v[176:191], v[28:31], v[212:215], v[176:191]
    buffer_load_dwordx4 v[208:211], v8, s[56:59], s91 offen offset:2048 sc1
    buffer_load_dwordx4 v[212:215], v9, s[56:59], s91 offen offset:2048 sc1
    s_waitcnt lgkmcnt(0)
    v_mov_b32 v15, 100
    ds_write_b32 v14, v15
    s_waitcnt vmcnt(12)
    s_waitcnt lgkmcnt(15)
    v_mfma_f32_32x32x16_bf16 v[128:143], v[32:35], v[216:219], v[128:143]
    v_mfma_f32_32x32x16_bf16 v[144:159], v[32:35], v[220:223], v[144:159]
    v_mfma_f32_32x32x16_bf16 v[160:175], v[36:39], v[216:219], v[160:175]
    v_mfma_f32_32x32x16_bf16 v[176:191], v[36:39], v[220:223], v[176:191]
    buffer_load_dwordx4 v[216:219], v8, s[56:59], s91 offen offset:3072 sc1
    buffer_load_dwordx4 v[220:223], v9, s[56:59], s91 offen offset:3072 sc1
    s_waitcnt vmcnt(12)
    s_waitcnt lgkmcnt(15)
    v_mfma_f32_32x32x16_bf16 v[128:143], v[40:43], v[224:227], v[128:143]
    v_mfma_f32_32x32x16_bf16 v[144:159], v[40:43], v[228:231], v[144:159]
    v_mfma_f32_32x32x16_bf16 v[160:175], v[44:47], v[224:227], v[160:175]
    v_mfma_f32_32x32x16_bf16 v[176:191], v[44:47], v[228:231], v[176:191]
    buffer_load_dwordx4 v[224:227], v8, s[56:59], s92 offen offset:2048 sc1
    buffer_load_dwordx4 v[228:231], v9, s[56:59], s92 offen offset:2048 sc1
    s_waitcnt vmcnt(12)
    s_waitcnt lgkmcnt(15)
    v_mfma_f32_32x32x16_bf16 v[128:143], v[48:51], v[232:235], v[128:143]
    v_mfma_f32_32x32x16_bf16 v[144:159], v[48:51], v[236:239], v[144:159]
    v_mfma_f32_32x32x16_bf16 v[160:175], v[52:55], v[232:235], v[160:175]
    v_mfma_f32_32x32x16_bf16 v[176:191], v[52:55], v[236:239], v[176:191]
    buffer_load_dwordx4 v[232:235], v8, s[56:59], s92 offen offset:3072 sc1
    buffer_load_dwordx4 v[236:239], v9, s[56:59], s92 offen offset:3072 sc1
    global_load_dword v3, v7, s[44:45] sc1
    s_mul_i32 s9, s3, 28672
    v_and_b32 v37, 31, v0
    v_mul_u32_u24 v37, 272, v37
    v_lshrrev_b32 v38, 5, v0
    v_lshl_add_u32 v37, v38, 4, v37
    v_add_u32 v32, s9, v37
    v_and_b32 v37, 15, v0
    s_waitcnt vmcnt(13)
    s_waitcnt lgkmcnt(15)
    v_mfma_f32_32x32x16_bf16 v[128:143], v[56:59], v[240:243], v[128:143]
    v_mfma_f32_32x32x16_bf16 v[144:159], v[56:59], v[244:247], v[144:159]
    v_mfma_f32_32x32x16_bf16 v[160:175], v[60:63], v[240:243], v[160:175]
    v_mfma_f32_32x32x16_bf16 v[176:191], v[60:63], v[244:247], v[176:191]
    buffer_load_dwordx4 v[240:243], v8, s[56:59], s93 offen offset:2048 sc1
    buffer_load_dwordx4 v[244:247], v9, s[56:59], s93 offen offset:2048 sc1
    v_lshrrev_b32 v38, 4, v0
    s_lshl_b32 s11, s3, 4
    v_add_u32 v33, s11, v37
    v_mul_u32_u24 v33, 272, v33
    v_lshl_add_u32 v33, v38, 5, v33
    v_lshrrev_b32 v35, 1, v38
    v_mul_u32_u24 v35, 28672, v35
    s_waitcnt vmcnt(13)
    s_waitcnt lgkmcnt(15)
    v_mfma_f32_32x32x16_bf16 v[128:143], v[64:67], v[192:195], v[128:143]
    v_mfma_f32_32x32x16_bf16 v[144:159], v[64:67], v[196:199], v[144:159]
    v_mfma_f32_32x32x16_bf16 v[160:175], v[68:71], v[192:195], v[160:175]
    v_mfma_f32_32x32x16_bf16 v[176:191], v[68:71], v[196:199], v[176:191]
    buffer_load_dwordx4 v[192:195], v8, s[56:59], s93 offen offset:3072 sc1
    buffer_load_dwordx4 v[196:199], v9, s[56:59], s93 offen offset:3072 sc1
    v_and_b32 v36, 1, v38
    v_lshlrev_b32 v36, 3, v36
    v_bfe_u32 v37, v0, 2, 2
    v_add_u32 v36, v36, v37
    v_mul_u32_u24 v36, 144, v36
    v_add_u32 v35, v35, v36
    v_and_b32 v36, 3, v0
    s_waitcnt vmcnt(13)
    s_waitcnt lgkmcnt(15)
    v_mfma_f32_32x32x16_bf16 v[128:143], v[72:75], v[200:203], v[128:143]
    v_mfma_f32_32x32x16_bf16 v[144:159], v[72:75], v[204:207], v[144:159]
    v_mfma_f32_32x32x16_bf16 v[160:175], v[76:79], v[200:203], v[160:175]
    v_mfma_f32_32x32x16_bf16 v[176:191], v[76:79], v[204:207], v[176:191]
    v_lshl_add_u32 v35, v36, 3, v35
    s_lshl_b32 s11, s3, 5
    v_add_u32 v35, s11, v35
    v_add_u32 v35, 17408, v35
    v_add_u32 v36, 57344, v35
    v_add_u32 v34, 57344, v33
    s_waitcnt vmcnt(11)
    s_waitcnt lgkmcnt(15)
    v_mfma_f32_32x32x16_bf16 v[128:143], v[80:83], v[208:211], v[128:143]
    v_mfma_f32_32x32x16_bf16 v[144:159], v[80:83], v[212:215], v[144:159]
    v_mfma_f32_32x32x16_bf16 v[160:175], v[84:87], v[208:211], v[160:175]
    v_mfma_f32_32x32x16_bf16 v[176:191], v[84:87], v[212:215], v[176:191]
    s_waitcnt vmcnt(4)
    v_cmp_ne_u32 vcc, s47, v3
    s_or_b32 s12, vcc_lo, vcc_hi
    buffer_load_dwordx4 v[24:27], v5, s[56:59], 0 offen sc1
    s_mov_b32 s11, 32768
    buffer_load_dwordx4 v[28:31], v5, s[56:59], s11 offen sc1
    buffer_load_dwordx4 v[16:19], v4, s[52:55], 0 offen
    buffer_load_dwordx4 v[20:23], v4, s[52:55], 0 offen offset:64
    s_waitcnt vmcnt(13)
    s_waitcnt lgkmcnt(15)
    v_mfma_f32_32x32x16_bf16 v[128:143], v[88:91], v[216:219], v[128:143]
    v_mfma_f32_32x32x16_bf16 v[144:159], v[88:91], v[220:223], v[144:159]
    v_mfma_f32_32x32x16_bf16 v[160:175], v[92:95], v[216:219], v[160:175]
    v_mfma_f32_32x32x16_bf16 v[176:191], v[92:95], v[220:223], v[176:191]
    global_load_dword v3, v7, s[44:45] sc1
    ds_read_b32 v249, v248
    s_waitcnt vmcnt(12)
    v_mfma_f32_32x32x16_bf16 v[128:143], v[96:99], v[224:227], v[128:143]
    v_mfma_f32_32x32x16_bf16 v[144:159], v[96:99], v[228:231], v[144:159]
    s_waitcnt vmcnt(10)
    v_mfma_f32_32x32x16_bf16 v[128:143], v[104:107], v[232:235], v[128:143]
    v_mfma_f32_32x32x16_bf16 v[144:159], v[104:107], v[236:239], v[144:159]
    s_waitcnt vmcnt(7)
    v_mfma_f32_32x32x16_bf16 v[128:143], v[112:115], v[240:243], v[128:143]
    v_mfma_f32_32x32x16_bf16 v[144:159], v[112:115], v[244:247], v[144:159]
    s_waitcnt vmcnt(5)
    v_mfma_f32_32x32x16_bf16 v[128:143], v[120:123], v[192:195], v[128:143]
    v_mfma_f32_32x32x16_bf16 v[144:159], v[120:123], v[196:199], v[144:159]
    s_waitcnt lgkmcnt(0)
    v_cmp_gt_u32 vcc, 100, v249
    s_cbranch_vccnz CF_52
CFB_53:
    v_mfma_f32_32x32x16_bf16 v[160:175], v[100:103], v[224:227], v[160:175]
    v_mfma_f32_32x32x16_bf16 v[176:191], v[100:103], v[228:231], v[176:191]
    s_nop 5
    ds_write_b128 v32, v[128:131] offset:0
    ds_write_b128 v32, v[132:135] offset:32
    v_mfma_f32_32x32x16_bf16 v[160:175], v[108:111], v[232:235], v[160:175]
    ds_write_b128 v32, v[136:139] offset:64
    ds_write_b128 v32, v[140:143] offset:96
    v_mfma_f32_32x32x16_bf16 v[176:191], v[108:111], v[236:239], v[176:191]
    ds_write_b128 v32, v[144:147] offset:8704
    ds_write_b128 v32, v[148:151] offset:8736
    v_mfma_f32_32x32x16_bf16 v[160:175], v[116:119], v[240:243], v[160:175]
    ds_write_b128 v32, v[152:155] offset:8768
    ds_write_b128 v32, v[156:159] offset:8800
    v_mfma_f32_32x32x16_bf16 v[176:191], v[116:119], v[244:247], v[176:191]
    v_mfma_f32_32x32x16_bf16 v[160:175], v[124:127], v[192:195], v[160:175]
    v_mfma_f32_32x32x16_bf16 v[176:191], v[124:127], v[196:199], v[176:191]
    s_cmp_lg_u32 s12, 0
    s_cbranch_scc1 CV2_54
CV2B_55:
    s_nop 8
    ds_write_b128 v32, v[160:163] offset:128
    ds_write_b128 v32, v[164:167] offset:160
    ds_write_b128 v32, v[168:171] offset:192
    ds_write_b128 v32, v[172:175] offset:224
    ds_write_b128 v32, v[176:179] offset:8832
    ds_write_b128 v32, v[180:183] offset:8864
    ds_write_b128 v32, v[184:187] offset:8896
    ds_write_b128 v32, v[188:191] offset:8928
    s_cmp_lg_u32 s12, 0
    s_cbranch_scc1 CVS_57
CVB_58:
    s_waitcnt vmcnt(0)
    ds_write_b128 v6, v[24:27] offset:17408
    ds_write_b128 v6, v[28:31] offset:18560
    v_mov_b32 v15, 200
    s_mov_b32 s70, 0xbfb8aa3b
    s_mov_b32 s71, 0xbfb8aa3b
    s_mov_b32 s72, 1.0
    s_mov_b32 s73, 1.0
    s_waitcnt lgkmcnt(0)
    ds_write_b32 v14, v15
SPIN_60:
    s_sub_u32 s69, s69, 1
    s_cbranch_scc1 recurrent_scan__ssm_conv_s4d__mixer_channel_mlp__prompt_kernel_BAIL
    ds_read_b32 v249, v248 offset:0
    s_waitcnt lgkmcnt(0)
    v_cmp_gt_u32 vcc, 200, v249
    s_cbranch_vccnz SPIN_60
    ds_read_b128 v[48:51], v33 offset:0
    ds_read_b128 v[52:55], v33 offset:16
    ds_read_b128 v[56:59], v33 offset:28672
    ds_read_b128 v[60:63], v33 offset:28688
    ds_read_b128 v[64:67], v34 offset:0
    ds_read_b128 v[68:71], v34 offset:16
    ds_read_b128 v[72:75], v34 offset:28672
    ds_read_b128 v[76:79], v34 offset:28688
    ds_read_b64_tr_b16 v[112:113], v35
    ds_read_b64_tr_b16 v[114:115], v35 offset:576
    ds_read_b128 v[80:83], v33 offset:128
    ds_read_b128 v[84:87], v33 offset:144
    ds_read_b128 v[88:91], v33 offset:28800
    ds_read_b128 v[92:95], v33 offset:28816
    ds_read_b128 v[96:99], v34 offset:128
    ds_read_b128 v[100:103], v34 offset:144
    ds_read_b128 v[104:107], v34 offset:28800
    ds_read_b128 v[108:111], v34 offset:28816
    ds_read_b64_tr_b16 v[116:117], v36
    ds_read_b64_tr_b16 v[118:119], v36 offset:576
    s_waitcnt lgkmcnt(10)
    v_pk_add_f32 v[48:49], v[48:49], v[56:57]
    v_pk_add_f32 v[64:65], v[64:65], v[72:73]
    v_lshlrev_b32 v122, 16, v112
    v_pk_add_f32 v[48:49], v[48:49], v[64:65]
    v_and_b32 v123, 0xffff0000, v112
    v_pk_mul_f32 v[120:121], v[48:49], s[70:71]
    v_exp_f32 v120, v120
    v_exp_f32 v121, v121
    v_pk_mul_f32 v[48:49], v[48:49], v[122:123]
    v_pk_add_f32 v[120:121], v[120:121], s[72:73]
    v_lshlrev_b32 v124, 16, v16
    v_rcp_f32 v120, v120
    v_rcp_f32 v121, v121
    v_and_b32 v125, 0xffff0000, v16
    v_pk_fma_f32 v[48:49], v[48:49], v[120:121], v[124:125]
    v_cvt_pk_bf16_f32 v136, v48, v49
    v_pk_add_f32 v[50:51], v[50:51], v[58:59]
    v_pk_add_f32 v[66:67], v[66:67], v[74:75]
    v_lshlrev_b32 v130, 16, v113
    v_pk_add_f32 v[50:51], v[50:51], v[66:67]
    v_and_b32 v131, 0xffff0000, v113
    v_pk_mul_f32 v[128:129], v[50:51], s[70:71]
    v_exp_f32 v128, v128
    v_exp_f32 v129, v129
    v_pk_mul_f32 v[50:51], v[50:51], v[130:131]
    v_pk_add_f32 v[128:129], v[128:129], s[72:73]
    v_lshlrev_b32 v132, 16, v17
    v_rcp_f32 v128, v128
    v_rcp_f32 v129, v129
    v_and_b32 v133, 0xffff0000, v17
    v_pk_fma_f32 v[50:51], v[50:51], v[128:129], v[132:133]
    v_cvt_pk_bf16_f32 v137, v50, v51
    v_pk_add_f32 v[52:53], v[52:53], v[60:61]
    v_pk_add_f32 v[68:69], v[68:69], v[76:77]
    v_lshlrev_b32 v122, 16, v114
    v_pk_add_f32 v[52:53], v[52:53], v[68:69]
    v_and_b32 v123, 0xffff0000, v114
    v_pk_mul_f32 v[120:121], v[52:53], s[70:71]
    v_exp_f32 v120, v120
    v_exp_f32 v121, v121
    v_pk_mul_f32 v[52:53], v[52:53], v[122:123]
    v_pk_add_f32 v[120:121], v[120:121], s[72:73]
    v_lshlrev_b32 v124, 16, v18
    v_rcp_f32 v120, v120
    v_rcp_f32 v121, v121
    v_and_b32 v125, 0xffff0000, v18
    v_pk_fma_f32 v[52:53], v[52:53], v[120:121], v[124:125]
    v_cvt_pk_bf16_f32 v138, v52, v53
    v_pk_add_f32 v[54:55], v[54:55], v[62:63]
    v_pk_add_f32 v[70:71], v[70:71], v[78:79]
    v_lshlrev_b32 v130, 16, v115
    v_pk_add_f32 v[54:55], v[54:55], v[70:71]
    v_and_b32 v131, 0xffff0000, v115
    v_pk_mul_f32 v[128:129], v[54:55], s[70:71]
    v_exp_f32 v128, v128
    v_exp_f32 v129, v129
    v_pk_mul_f32 v[54:55], v[54:55], v[130:131]
    v_pk_add_f32 v[128:129], v[128:129], s[72:73]
    v_lshlrev_b32 v132, 16, v19
    v_rcp_f32 v128, v128
    v_rcp_f32 v129, v129
    v_and_b32 v133, 0xffff0000, v19
    v_pk_fma_f32 v[54:55], v[54:55], v[128:129], v[132:133]
    v_cvt_pk_bf16_f32 v139, v54, v55
    buffer_store_dwordx4 v[136:139], v4, s[60:63], 0 offen offset:0
    s_waitcnt lgkmcnt(0)
    v_pk_add_f32 v[80:81], v[80:81], v[88:89]
    v_pk_add_f32 v[96:97], v[96:97], v[104:105]
    v_lshlrev_b32 v122, 16, v116
    v_pk_add_f32 v[80:81], v[80:81], v[96:97]
    v_and_b32 v123, 0xffff0000, v116
    v_pk_mul_f32 v[120:121], v[80:81], s[70:71]
    v_exp_f32 v120, v120
    v_exp_f32 v121, v121
    v_pk_mul_f32 v[80:81], v[80:81], v[122:123]
    v_pk_add_f32 v[120:121], v[120:121], s[72:73]
    v_lshlrev_b32 v124, 16, v20
    v_rcp_f32 v120, v120
    v_rcp_f32 v121, v121
    v_and_b32 v125, 0xffff0000, v20
    v_pk_fma_f32 v[80:81], v[80:81], v[120:121], v[124:125]
    v_cvt_pk_bf16_f32 v140, v80, v81
    v_pk_add_f32 v[82:83], v[82:83], v[90:91]
    v_pk_add_f32 v[98:99], v[98:99], v[106:107]
    v_lshlrev_b32 v130, 16, v117
    v_pk_add_f32 v[82:83], v[82:83], v[98:99]
    v_and_b32 v131, 0xffff0000, v117
    v_pk_mul_f32 v[128:129], v[82:83], s[70:71]
    v_exp_f32 v128, v128
    v_exp_f32 v129, v129
    v_pk_mul_f32 v[82:83], v[82:83], v[130:131]
    v_pk_add_f32 v[128:129], v[128:129], s[72:73]
    v_lshlrev_b32 v132, 16, v21
    v_rcp_f32 v128, v128
    v_rcp_f32 v129, v129
    v_and_b32 v133, 0xffff0000, v21
    v_pk_fma_f32 v[82:83], v[82:83], v[128:129], v[132:133]
    v_cvt_pk_bf16_f32 v141, v82, v83
    v_pk_add_f32 v[84:85], v[84:85], v[92:93]
    v_pk_add_f32 v[100:101], v[100:101], v[108:109]
    v_lshlrev_b32 v122, 16, v118
    v_pk_add_f32 v[84:85], v[84:85], v[100:101]
    v_and_b32 v123, 0xffff0000, v118
    v_pk_mul_f32 v[120:121], v[84:85], s[70:71]
    v_exp_f32 v120, v120
    v_exp_f32 v121, v121
    v_pk_mul_f32 v[84:85], v[84:85], v[122:123]
    v_pk_add_f32 v[120:121], v[120:121], s[72:73]
    v_lshlrev_b32 v124, 16, v22
    v_rcp_f32 v120, v120
    v_rcp_f32 v121, v121
    v_and_b32 v125, 0xffff0000, v22
    v_pk_fma_f32 v[84:85], v[84:85], v[120:121], v[124:125]
    v_cvt_pk_bf16_f32 v142, v84, v85
    v_pk_add_f32 v[86:87], v[86:87], v[94:95]
    v_pk_add_f32 v[102:103], v[102:103], v[110:111]
    v_lshlrev_b32 v130, 16, v119
    v_pk_add_f32 v[86:87], v[86:87], v[102:103]
    v_and_b32 v131, 0xffff0000, v119
    v_pk_mul_f32 v[128:129], v[86:87], s[70:71]
    v_exp_f32 v128, v128
    v_exp_f32 v129, v129
    v_pk_mul_f32 v[86:87], v[86:87], v[130:131]
    v_pk_add_f32 v[128:129], v[128:129], s[72:73]
    v_lshlrev_b32 v132, 16, v23
    v_rcp_f32 v128, v128
    v_rcp_f32 v129, v129
    v_and_b32 v133, 0xffff0000, v23
    v_pk_fma_f32 v[86:87], v[86:87], v[128:129], v[132:133]
    v_cvt_pk_bf16_f32 v143, v86, v87
    buffer_store_dwordx4 v[140:143], v4, s[60:63], 0 offen offset:64
    s_or_b32 s10, s2, s3
    s_cmp_lg_u32 s10, 0
    s_cbranch_scc1 G2_NOEP
    s_add_u32 s10, s46, 1
    v_mov_b32 v1, 11024384
    v_mov_b32 v2, s10
    s_mov_b64 exec, 1
    global_store_dword v1, v2, s[44:45]
    s_mov_b64 exec, -1
G2_NOEP:
    s_branch recurrent_scan__ssm_conv_s4d__mixer_channel_mlp__prompt_kernel_END
R_KC:
    s_sub_u32 s5, s3, 4
    v_and_b32 v1, 31, v0
    v_lshlrev_b32 v1, 2, v1
    v_lshrrev_b32 v2, 5, v0
    v_mul_u32_u24 v2, 24576, v2
    v_add_u32 v1, v1, v2
    v_mov_b32 v2, 0
    v_add_u32 v1, 138752, v1
    ds_write_b32 v1, v2
    s_mul_i32 s4, s78, 28
    s_add_u32 s4, s4, s79
    s_lshr_b32 s6, s5, 1
    s_and_b32 s7, s5, 1
    s_lshl_b32 s8, s4, 1
    s_add_u32 s8, s8, s6
    s_mul_i32 s9, s6, 24576
    s_add_u32 s9, s9, 114688
    s_lshl_b32 s10, s8, 9
    s_lshl_b32 s11, s7, 8
    s_add_u32 s10, s10, s11
    v_lshl_add_u32 v1, v0, 2, s10
    s_lshl_b32 s10, s4, 2
    s_waitcnt lgkmcnt(0)
    global_load_dword v233, v1, s[18:19]
    global_load_dword v234, v1, s[20:21]
    global_load_dword v235, v1, s[22:23]
    global_load_dword v236, v1, s[24:25]
    s_barrier
    s_load_dword s12, s[26:27], s10
    s_load_dword s13, s[28:29], s10
    s_mov_b32 s70, s4
    s_mov_b32 s71, s5
    s_mov_b32 s72, s8
    s_mov_b32 s73, s9
    s_mov_b32 s75, s7
    s_mov_b32 s77, s6
    s_and_b32 s80, s2, 31
    s_lshl_b32 s80, s80, 7
    s_add_u32 s80, s80, 11010048
    s_add_u32 s6, s44, 11024384
    s_addc_u32 s7, s45, 0
    s_load_dword s46, s[6:7], 0
    s_mov_b32 s7, s75
    s_mov_b32 s56, s44
    s_mov_b32 s57, s45
    s_mov_b32 s58, 0x1000000
    s_mov_b32 s59, 0x00020000
    v_mov_b32 v12, 0
    s_cmp_lg_u32 s7, 0
    s_cbranch_scc1 KC_Z1
    s_mov_b64 exec, 15
    v_lshl_add_u32 v1, v0, 2, s9
    ds_write_b32 v1, v12 offset:21484
    s_mov_b64 exec, -1
KC_Z1:
    s_lshl_b32 s10, s7, 10
    s_sub_u32 s10, s10, 4
    v_lshl_add_u32 v16, v0, 3, s10
    s_add_u32 s11, s9, 17404
    s_sub_u32 s14, s11, 68096
    s_add_u32 s15, s11, 512
    v_cvt_f32_i32 v17, v16
    v_lshl_add_u32 v18, v16, 2, s11
    v_add_f32 v20, 0x0, v17
    v_add_f32 v21, 0x3f800000, v17
    v_cvt_pk_bf16_f32 v20, v20, v21
    v_bfe_i32 v21, v20, 0, 16
    v_ashrrev_i32 v20, 16, v20
    v_lshl_add_u32 v21, v21, 2, s14
    v_lshl_add_u32 v20, v20, 2, s14
    v_add_u32 v22, 0, v18
    v_add_u32 v23, 4, v18
    v_med3_i32 v204, v22, s15, v21
    v_med3_i32 v205, v23, s15, v20
    v_add_f32 v20, 0x40000000, v17
    v_add_f32 v21, 0x40400000, v17
    v_cvt_pk_bf16_f32 v20, v20, v21
    v_bfe_i32 v21, v20, 0, 16
    v_ashrrev_i32 v20, 16, v20
    v_lshl_add_u32 v21, v21, 2, s14
    v_lshl_add_u32 v20, v20, 2, s14
    v_add_u32 v22, 8, v18
    v_add_u32 v23, 12, v18
    v_med3_i32 v206, v22, s15, v21
    v_med3_i32 v207, v23, s15, v20
    v_add_f32 v20, 0x40800000, v17
    v_add_f32 v21, 0x40a00000, v17
    v_cvt_pk_bf16_f32 v20, v20, v21
    v_bfe_i32 v21, v20, 0, 16
    v_ashrrev_i32 v20, 16, v20
    v_lshl_add_u32 v21, v21, 2, s14
    v_lshl_add_u32 v20, v20, 2, s14
    v_add_u32 v22, 16, v18
    v_add_u32 v23, 20, v18
    v_med3_i32 v208, v22, s15, v21
    v_med3_i32 v209, v23, s15, v20
    v_add_f32 v20, 0x40c00000, v17
    v_add_f32 v21, 0x40e00000, v17
    v_cvt_pk_bf16_f32 v20, v20, v21
    v_bfe_i32 v21, v20, 0, 16
    v_ashrrev_i32 v20, 16, v20
    v_lshl_add_u32 v21, v21, 2, s14
    v_lshl_add_u32 v20, v20, 2, s14
    v_add_u32 v22, 24, v18
    v_add_u32 v23, 28, v18
    v_med3_i32 v210, v22, s15, v21
    v_med3_i32 v211, v23, s15, v20
    v_add_f32 v20, 0x41000000, v17
    v_add_f32 v21, 0x41100000, v17
    v_cvt_pk_bf16_f32 v20, v20, v21
    v_bfe_i32 v21, v20, 0, 16
    v_ashrrev_i32 v20, 16, v20
    v_lshl_add_u32 v21, v21, 2, s14
    v_lshl_add_u32 v20, v20, 2, s14
    v_add_u32 v22, 32, v18
    v_add_u32 v23, 36, v18
    v_med3_i32 v212, v22, s15, v21
    v_med3_i32 v213, v23, s15, v20
    v_add_f32 v20, 0x41200000, v17
    v_add_f32 v21, 0x41300000, v17
    v_cvt_pk_bf16_f32 v20, v20, v21
    v_bfe_i32 v21, v20, 0, 16
    v_ashrrev_i32 v20, 16, v20
    v_lshl_add_u32 v21, v21, 2, s14
    v_lshl_add_u32 v20, v20, 2, s14
    v_add_u32 v22, 40, v18
    v_add_u32 v23, 44, v18
    v_med3_i32 v214, v22, s15, v21
    v_med3_i32 v215, v23, s15, v20
    v_add_f32 v20, 0x44000000, v17
    v_add_f32 v21, 0x44004000, v17
    v_cvt_pk_bf16_f32 v20, v20, v21
    v_bfe_i32 v21, v20, 0, 16
    v_ashrrev_i32 v20, 16, v20
    v_lshl_add_u32 v21, v21, 2, s14
    v_lshl_add_u32 v20, v20, 2, s14
    v_add_u32 v22, 2048, v18
    v_add_u32 v23, 2052, v18
    v_med3_i32 v216, v22, s15, v21
    v_med3_i32 v217, v23, s15, v20
    v_add_f32 v20, 0x44008000, v17
    v_add_f32 v21, 0x4400c000, v17
    v_cvt_pk_bf16_f32 v20, v20, v21
    v_bfe_i32 v21, v20, 0, 16
    v_ashrrev_i32 v20, 16, v20
    v_lshl_add_u32 v21, v21, 2, s14
    v_lshl_add_u32 v20, v20, 2, s14
    v_add_u32 v22, 2056, v18
    v_add_u32 v23, 2060, v18
    v_med3_i32 v218, v22, s15, v21
    v_med3_i32 v219, v23, s15, v20
    v_add_f32 v20, 0x44010000, v17
    v_add_f32 v21, 0x44014000, v17
    v_cvt_pk_bf16_f32 v20, v20, v21
    v_bfe_i32 v21, v20, 0, 16
    v_ashrrev_i32 v20, 16, v20
    v_lshl_add_u32 v21, v21, 2, s14
    v_lshl_add_u32 v20, v20, 2, s14
    v_add_u32 v22, 2064, v18
    v_add_u32 v23, 2068, v18
    v_med3_i32 v220, v22, s15, v21
    v_med3_i32 v221, v23, s15, v20
    v_add_f32 v20, 0x44018000, v17
    v_add_f32 v21, 0x4401c000, v17
    v_cvt_pk_bf16_f32 v20, v20, v21
    v_bfe_i32 v21, v20, 0, 16
    v_ashrrev_i32 v20, 16, v20
    v_lshl_add_u32 v21, v21, 2, s14
    v_lshl_add_u32 v20, v20, 2, s14
    v_add_u32 v22, 2072, v18
    v_add_u32 v23, 2076, v18
    v_med3_i32 v222, v22, s15, v21
    v_med3_i32 v223, v23, s15, v20
    v_add_f32 v20, 0x44020000, v17
    v_add_f32 v21, 0x44024000, v17
    v_cvt_pk_bf16_f32 v20, v20, v21
    v_bfe_i32 v21, v20, 0, 16
    v_ashrrev_i32 v20, 16, v20
    v_lshl_add_u32 v21, v21, 2, s14
    v_lshl_add_u32 v20, v20, 2, s14
    v_add_u32 v22, 2080, v18
    v_add_u32 v23, 2084, v18
    v_med3_i32 v224, v22, s15, v21
    v_med3_i32 v225, v23, s15, v20
    v_add_f32 v20, 0x44028000, v17
    v_add_f32 v21, 0x4402c000, v17
    v_cvt_pk_bf16_f32 v20, v20, v21
    v_bfe_i32 v21, v20, 0, 16
    v_ashrrev_i32 v20, 16, v20
    v_lshl_add_u32 v21, v21, 2, s14
    v_lshl_add_u32 v20, v20, 2, s14
    v_add_u32 v22, 2088, v18
    v_add_u32 v23, 2092, v18
    v_med3_i32 v226, v22, s15, v21
    v_med3_i32 v227, v23, s15, v20
    s_xor_b32 s10, s7, 1
    s_lshl_b32 s10, s10, 12
    s_add_u32 s11, s11, s10
    v_lshrrev_b32 v4, 4, v0
    v_and_b32 v1, 15, v0
    v_lshlrev_b32 v20, 4, v1
    v_lshl_add_u32 v20, v4, 2, v20
    v_lshl_add_u32 v228, v20, 2, s11
    v_add_u32 v228, 4, v228
    v_lshlrev_b32 v20, 3, v1
    v_lshl_add_u32 v20, v4, 2, v20
    v_add_u32 v20, 257, v20
    v_lshlrev_b32 v21, 2, v1
    v_lshl_add_u32 v21, v4, 6, v21
    v_add_u32 v21, 257, v21
    v_cmp_gt_u32 vcc, 2, v4
    s_nop 1
    v_cndmask_b32 v20, v21, v20, vcc
    v_lshl_add_u32 v229, v20, 2, s11
    v_lshlrev_b32 v20, 1, v1
    v_lshl_add_u32 v20, v4, 6, v20
    v_add_u32 v20, 513, v20
    v_lshl_add_u32 v230, v20, 2, s11
    s_mov_b32 s74, s11
    s_mov_b32 s9, s73
    s_lshl_b32 s10, s7, 2
    s_add_u32 s10, s10, s9
    s_add_u32 s10, s10, 24128
    v_mov_b32 v6, s10
    s_xor_b32 s10, s10, 4
    v_mov_b32 v7, s10
    s_mul_i32 s10, s7, 8704
    s_add_u32 s10, s10, s9
    v_lshl_add_u32 v24, v0, 3, s10
    v_add_u32 v25, 2176, v24
    v_add_u32 v26, 4352, v24
    v_add_u32 v27, 6528, v24
    v_and_b32 v1, 15, v0
    v_mul_u32_u24 v3, 544, v1
    v_lshrrev_b32 v4, 4, v0
    v_lshl_add_u32 v3, v4, 4, v3
    v_add_u32 v3, s10, v3
    s_waitcnt lgkmcnt(0)
    s_mul_i32 s47, s46, 0x9E3779B1
    s_add_u32 s47, s47, 0x7F4A7C15
    s_lshl_b32 s10, s77, 4
    s_lshr_b32 s12, s12, s10
    s_lshl_b32 s76, s12, 16
    s_lshr_b32 s13, s13, s10
    s_lshl_b32 s77, s13, 16
    v_mov_b32 v1, 0x3fb8aa3b
    v_mul_f32 v4, s76, v1
    v_exp_f32 v4, v4
    s_nop 0
    v_cvt_pk_bf16_f32 v4, v4, v4
    v_and_b32 v4, 0xffff0000, v4
    v_mov_b32 v12, 138784
    v_mov_b32 v14, s46
    v_mov_b32 v15, 1
    ds_write_b64 v12, v[14:15]
    s_getreg_b32 s15, hwreg(HW_REG_XCC_ID)
    s_lshl_b32 s10, s78, 8
    s_add_u32 s10, s10, 11059200
    s_lshr_b32 s11, s2, 3
    s_lshl_b32 s11, s11, 3
    s_add_u32 s11, s11, s10
    v_mov_b32 v12, s11
    v_mov_b32 v14, s47
    v_mov_b32 v15, s15
    s_waitcnt vmcnt(0)
    s_cmp_lg_u32 s71, 0
    s_cbranch_scc1 KC_NOX
    s_mov_b64 exec, 1
    global_store_dwordx2 v12, v[14:15], s[44:45] sc1
    s_mov_b64 exec, -1
KC_NOX:
    v_lshlrev_b32 v12, 16, v233
    v_and_b32 v13, 0xffff0000, v233
    v_mul_f32 v12, v12, v1
    v_mul_f32 v13, v13, v1
    v_exp_f32 v12, v12
    v_exp_f32 v13, v13
    s_nop 0
    v_cvt_pk_bf16_f32 v12, v12, v13
    v_lshlrev_b32 v14, 16, v12
    v_and_b32 v15, 0xffff0000, v12
    v_mul_f32 v14, v14, v4
    v_mul_f32 v15, v15, v4
    v_mul_f32 v14, v14, v1
    v_mul_f32 v15, v15, v1
    v_exp_f32 v14, -v14
    v_exp_f32 v15, -v15
    v_lshlrev_b32 v16, 16, v234
    v_and_b32 v17, 0xffff0000, v234
    v_mul_f32 v16, v16, v4
    v_mul_f32 v17, v17, v4
    v_mul_f32 v16, 0.15915494, v16
    v_mul_f32 v17, 0.15915494, v17
    v_rndne_f32 v18, v16
    v_rndne_f32 v19, v17
    v_sub_f32 v16, v16, v18
    v_sub_f32 v17, v17, v19
    v_cos_f32 v18, v16
    v_sin_f32 v19, v16
    v_cos_f32 v20, v17
    v_sin_f32 v21, v17
    v_mul_f32 v32, v14, v18
    v_mul_f32 v33, v14, v19
    v_mul_f32 v34, v15, v20
    v_mul_f32 v35, v15, v21
    v_add_f32 v4, v4, v4
    v_lshlrev_b32 v16, 16, v235
    v_and_b32 v17, 0xffff0000, v235
    v_lshlrev_b32 v18, 16, v236
    v_and_b32 v19, 0xffff0000, v236
    v_mul_f32 v56, v16, v4
    v_mul_f32 v57, v18, v4
    v_mul_f32 v58, v17, v4
    v_mul_f32 v59, v19, v4
    v_mul_f32 v8, v33, v33
    v_mul_f32 v9, v32, v33
    v_mul_f32 v10, v35, v35
    v_mul_f32 v11, v34, v35
    v_fma_f32 v36, v32, v32, -v8
    v_fma_f32 v37, v33, v32, v9
    v_fma_f32 v38, v34, v34, -v10
    v_fma_f32 v39, v35, v34, v11
    v_mul_f32 v8, v37, v37
    v_mul_f32 v9, v36, v37
    v_mul_f32 v10, v39, v39
    v_mul_f32 v11, v38, v39
    v_fma_f32 v40, v36, v36, -v8
    v_fma_f32 v41, v37, v36, v9
    v_fma_f32 v42, v38, v38, -v10
    v_fma_f32 v43, v39, v38, v11
    v_mul_f32 v8, v41, v41
    v_mul_f32 v9, v40, v41
    v_mul_f32 v10, v43, v43
    v_mul_f32 v11, v42, v43
    v_fma_f32 v44, v40, v40, -v8
    v_fma_f32 v45, v41, v40, v9
    v_fma_f32 v46, v42, v42, -v10
    v_fma_f32 v47, v43, v42, v11
    v_mul_f32 v8, v45, v45
    v_mul_f32 v9, v44, v45
    v_mul_f32 v10, v47, v47
    v_mul_f32 v11, v46, v47
    v_fma_f32 v48, v44, v44, -v8
    v_fma_f32 v49, v45, v44, v9
    v_fma_f32 v50, v46, v46, -v10
    v_fma_f32 v51, v47, v46, v11
    v_mov_b32 v22, 0x3f80
    v_mov_b32 v23, 0x3f80
    v_mov_b64 v[52:53], v[48:49]
    v_mov_b64 v[54:55], v[50:51]
    ds_write_b64 v24, v[22:23] offset:0
    v_cvt_pk_bf16_f32 v16, v52, -v53
    v_cvt_pk_bf16_f32 v17, v54, -v55
    v_mul_f32 v8, v53, v49
    v_mul_f32 v9, v52, v49
    v_mul_f32 v10, v55, v51
    v_mul_f32 v11, v54, v51
    v_fma_f32 v52, v52, v48, -v8
    v_fma_f32 v53, v53, v48, v9
    v_fma_f32 v54, v54, v50, -v10
    v_fma_f32 v55, v55, v50, v11
    ds_write_b64 v24, v[16:17] offset:544
    v_cvt_pk_bf16_f32 v18, v52, -v53
    v_cvt_pk_bf16_f32 v19, v54, -v55
    v_mul_f32 v8, v53, v49
    v_mul_f32 v9, v52, v49
    v_mul_f32 v10, v55, v51
    v_mul_f32 v11, v54, v51
    v_fma_f32 v52, v52, v48, -v8
    v_fma_f32 v53, v53, v48, v9
    v_fma_f32 v54, v54, v50, -v10
    v_fma_f32 v55, v55, v50, v11
    v_cvt_pk_bf16_f32 v20, v52, -v53
    v_cvt_pk_bf16_f32 v21, v54, -v55
    v_mul_f32 v8, v53, v49
    v_mul_f32 v9, v52, v49
    v_mul_f32 v10, v55, v51
    v_mul_f32 v11, v54, v51
    v_fma_f32 v52, v52, v48, -v8
    v_fma_f32 v53, v53, v48, v9
    v_fma_f32 v54, v54, v50, -v10
    v_fma_f32 v55, v55, v50, v11
    ds_write2_b64 v24, v[18:19], v[20:21] offset0:136 offset1:204
    v_cvt_pk_bf16_f32 v22, v52, -v53
    v_cvt_pk_bf16_f32 v23, v54, -v55
    v_mul_f32 v8, v53, v49
    v_mul_f32 v9, v52, v49
    v_mul_f32 v10, v55, v51
    v_mul_f32 v11, v54, v51
    v_fma_f32 v52, v52, v48, -v8
    v_fma_f32 v53, v53, v48, v9
    v_fma_f32 v54, v54, v50, -v10
    v_fma_f32 v55, v55, v50, v11
    v_cvt_pk_bf16_f32 v16, v52, -v53
    v_cvt_pk_bf16_f32 v17, v54, -v55
    v_mul_f32 v8, v53, v49
    v_mul_f32 v9, v52, v49
    v_mul_f32 v10, v55, v51
    v_mul_f32 v11, v54, v51
    v_fma_f32 v52, v52, v48, -v8
    v_fma_f32 v53, v53, v48, v9
    v_fma_f32 v54, v54, v50, -v10
    v_fma_f32 v55, v55, v50, v11
    ds_write2_b64 v25, v[22:23], v[16:17] offset0:0 offset1:68
    v_cvt_pk_bf16_f32 v18, v52, -v53
    v_cvt_pk_bf16_f32 v19, v54, -v55
    v_mul_f32 v8, v53, v49
    v_mul_f32 v9, v52, v49
    v_mul_f32 v10, v55, v51
    v_mul_f32 v11, v54, v51
    v_fma_f32 v52, v52, v48, -v8
    v_fma_f32 v53, v53, v48, v9
    v_fma_f32 v54, v54, v50, -v10
    v_fma_f32 v55, v55, v50, v11
    v_cvt_pk_bf16_f32 v20, v52, -v53
    v_cvt_pk_bf16_f32 v21, v54, -v55
    v_mul_f32 v8, v53, v49
    v_mul_f32 v9, v52, v49
    v_mul_f32 v10, v55, v51
    v_mul_f32 v11, v54, v51
    v_fma_f32 v52, v52, v48, -v8
    v_fma_f32 v53, v53, v48, v9
    v_fma_f32 v54, v54, v50, -v10
    v_fma_f32 v55, v55, v50, v11
    ds_write2_b64 v25, v[18:19], v[20:21] offset0:136 offset1:204
    v_cvt_pk_bf16_f32 v22, v52, -v53
    v_cvt_pk_bf16_f32 v23, v54, -v55
    v_mul_f32 v8, v53, v49
    v_mul_f32 v9, v52, v49
    v_mul_f32 v10, v55, v51
    v_mul_f32 v11, v54, v51
    v_fma_f32 v52, v52, v48, -v8
    v_fma_f32 v53, v53, v48, v9
    v_fma_f32 v54, v54, v50, -v10
    v_fma_f32 v55, v55, v50, v11
    v_cvt_pk_bf16_f32 v16, v52, -v53
    v_cvt_pk_bf16_f32 v17, v54, -v55
    v_mul_f32 v8, v53, v49
    v_mul_f32 v9, v52, v49
    v_mul_f32 v10, v55, v51
    v_mul_f32 v11, v54, v51
    v_fma_f32 v52, v52, v48, -v8
    v_fma_f32 v53, v53, v48, v9
    v_fma_f32 v54, v54, v50, -v10
    v_fma_f32 v55, v55, v50, v11
    ds_write2_b64 v26, v[22:23], v[16:17] offset0:0 offset1:68
    v_cvt_pk_bf16_f32 v18, v52, -v53
    v_cvt_pk_bf16_f32 v19, v54, -v55
    v_mul_f32 v8, v53, v49
    v_mul_f32 v9, v52, v49
    v_mul_f32 v10, v55, v51
    v_mul_f32 v11, v54, v51
    v_fma_f32 v52, v52, v48, -v8
    v_fma_f32 v53, v53, v48, v9
    v_fma_f32 v54, v54, v50, -v10
    v_fma_f32 v55, v55, v50, v11
    v_cvt_pk_bf16_f32 v20, v52, -v53
    v_cvt_pk_bf16_f32 v21, v54, -v55
    v_mul_f32 v8, v53, v49
    v_mul_f32 v9, v52, v49
    v_mul_f32 v10, v55, v51
    v_mul_f32 v11, v54, v51
    v_fma_f32 v52, v52, v48, -v8
    v_fma_f32 v53, v53, v48, v9
    v_fma_f32 v54, v54, v50, -v10
    v_fma_f32 v55, v55, v50, v11
    ds_write2_b64 v26, v[18:19], v[20:21] offset0:136 offset1:204
    v_cvt_pk_bf16_f32 v22, v52, -v53
    v_cvt_pk_bf16_f32 v23, v54, -v55
    v_mul_f32 v8, v53, v49
    v_mul_f32 v9, v52, v49
    v_mul_f32 v10, v55, v51
    v_mul_f32 v11, v54, v51
    v_fma_f32 v52, v52, v48, -v8
    v_fma_f32 v53, v53, v48, v9
    v_fma_f32 v54, v54, v50, -v10
    v_fma_f32 v55, v55, v50, v11
    v_cvt_pk_bf16_f32 v16, v52, -v53
    v_cvt_pk_bf16_f32 v17, v54, -v55
    v_mul_f32 v8, v53, v49
    v_mul_f32 v9, v52, v49
    v_mul_f32 v10, v55, v51
    v_mul_f32 v11, v54, v51
    v_fma_f32 v52, v52, v48, -v8
    v_fma_f32 v53, v53, v48, v9
    v_fma_f32 v54, v54, v50, -v10
    v_fma_f32 v55, v55, v50, v11
    ds_write2_b64 v27, v[22:23], v[16:17] offset0:0 offset1:68
    v_cvt_pk_bf16_f32 v18, v52, -v53
    v_cvt_pk_bf16_f32 v19, v54, -v55
    v_mul_f32 v8, v53, v49
    v_mul_f32 v9, v52, v49
    v_mul_f32 v10, v55, v51
    v_mul_f32 v11, v54, v51
    v_fma_f32 v52, v52, v48, -v8
    v_fma_f32 v53, v53, v48, v9
    v_fma_f32 v54, v54, v50, -v10
    v_fma_f32 v55, v55, v50, v11
    v_cvt_pk_bf16_f32 v20, v52, -v53
    v_cvt_pk_bf16_f32 v21, v54, -v55
    v_mul_f32 v8, v53, v49
    v_mul_f32 v9, v52, v49
    v_mul_f32 v10, v55, v51
    v_mul_f32 v11, v54, v51
    v_fma_f32 v52, v52, v48, -v8
    v_fma_f32 v53, v53, v48, v9
    v_fma_f32 v54, v54, v50, -v10
    v_fma_f32 v55, v55, v50, v11
    ds_write2_b64 v27, v[18:19], v[20:21] offset0:136 offset1:204
    ds_read_b128 v[108:111], v3 offset:0
    ds_read_b128 v[112:115], v3 offset:64
    ds_read_b128 v[116:119], v3 offset:128
    ds_read_b128 v[120:123], v3 offset:192
    ds_read_b128 v[124:127], v3 offset:256
    ds_read_b128 v[128:131], v3 offset:320
    ds_read_b128 v[132:135], v3 offset:384
    ds_read_b128 v[136:139], v3 offset:448
    v_mov_b64 v[72:73], v[52:53]
    v_mov_b64 v[74:75], v[54:55]
    v_mul_f32 v8, v57, v33
    v_mul_f32 v9, v56, v33
    v_mul_f32 v10, v59, v35
    v_mul_f32 v11, v58, v35
    v_fma_f32 v52, v56, v32, -v8
    v_fma_f32 v53, v57, v32, v9
    v_fma_f32 v54, v58, v34, -v10
    v_fma_f32 v55, v59, v34, v11
    v_cvt_pk_bf16_f32 v22, v52, v53
    v_cvt_pk_bf16_f32 v23, v54, v55
    v_mul_f32 v8, v53, v33
    v_mul_f32 v9, v52, v33
    v_mul_f32 v10, v55, v35
    v_mul_f32 v11, v54, v35
    v_fma_f32 v52, v52, v32, -v8
    v_fma_f32 v53, v53, v32, v9
    v_fma_f32 v54, v54, v34, -v10
    v_fma_f32 v55, v55, v34, v11
    v_cvt_pk_bf16_f32 v16, v52, v53
    v_cvt_pk_bf16_f32 v17, v54, v55
    v_mov_b64 v[60:61], v[52:53]
    v_mov_b64 v[62:63], v[54:55]
    v_mul_f32 v8, v53, v33
    v_mul_f32 v9, v52, v33
    v_mul_f32 v10, v55, v35
    v_mul_f32 v11, v54, v35
    v_fma_f32 v52, v52, v32, -v8
    v_fma_f32 v53, v53, v32, v9
    v_fma_f32 v54, v54, v34, -v10
    v_fma_f32 v55, v55, v34, v11
    ds_write2_b64 v24, v[22:23], v[16:17] offset0:0 offset1:68
    v_cvt_pk_bf16_f32 v18, v52, v53
    v_cvt_pk_bf16_f32 v19, v54, v55
    v_mul_f32 v8, v53, v33
    v_mul_f32 v9, v52, v33
    v_mul_f32 v10, v55, v35
    v_mul_f32 v11, v54, v35
    v_fma_f32 v52, v52, v32, -v8
    v_fma_f32 v53, v53, v32, v9
    v_fma_f32 v54, v54, v34, -v10
    v_fma_f32 v55, v55, v34, v11
    v_cvt_pk_bf16_f32 v20, v52, v53
    v_cvt_pk_bf16_f32 v21, v54, v55
    v_mov_b64 v[64:65], v[52:53]
    v_mov_b64 v[66:67], v[54:55]
    v_mul_f32 v8, v53, v33
    v_mul_f32 v9, v52, v33
    v_mul_f32 v10, v55, v35
    v_mul_f32 v11, v54, v35
    v_fma_f32 v52, v52, v32, -v8
    v_fma_f32 v53, v53, v32, v9
    v_fma_f32 v54, v54, v34, -v10
    v_fma_f32 v55, v55, v34, v11
    ds_write2_b64 v24, v[18:19], v[20:21] offset0:136 offset1:204
    v_cvt_pk_bf16_f32 v22, v52, v53
    v_cvt_pk_bf16_f32 v23, v54, v55
    v_mul_f32 v8, v53, v33
    v_mul_f32 v9, v52, v33
    v_mul_f32 v10, v55, v35
    v_mul_f32 v11, v54, v35
    v_fma_f32 v52, v52, v32, -v8
    v_fma_f32 v53, v53, v32, v9
    v_fma_f32 v54, v54, v34, -v10
    v_fma_f32 v55, v55, v34, v11
    v_cvt_pk_bf16_f32 v16, v52, v53
    v_cvt_pk_bf16_f32 v17, v54, v55
    v_mul_f32 v8, v53, v33
    v_mul_f32 v9, v52, v33
    v_mul_f32 v10, v55, v35
    v_mul_f32 v11, v54, v35
    v_fma_f32 v52, v52, v32, -v8
    v_fma_f32 v53, v53, v32, v9
    v_fma_f32 v54, v54, v34, -v10
    v_fma_f32 v55, v55, v34, v11
    ds_write2_b64 v25, v[22:23], v[16:17] offset0:0 offset1:68
    v_cvt_pk_bf16_f32 v18, v52, v53
    v_cvt_pk_bf16_f32 v19, v54, v55
    v_mul_f32 v8, v53, v33
    v_mul_f32 v9, v52, v33
    v_mul_f32 v10, v55, v35
    v_mul_f32 v11, v54, v35
    v_fma_f32 v52, v52, v32, -v8
    v_fma_f32 v53, v53, v32, v9
    v_fma_f32 v54, v54, v34, -v10
    v_fma_f32 v55, v55, v34, v11
    v_cvt_pk_bf16_f32 v20, v52, v53
    v_cvt_pk_bf16_f32 v21, v54, v55
    v_mov_b64 v[68:69], v[52:53]
    v_mov_b64 v[70:71], v[54:55]
    v_mul_f32 v8, v53, v33
    v_mul_f32 v9, v52, v33
    v_mul_f32 v10, v55, v35
    v_mul_f32 v11, v54, v35
    v_fma_f32 v52, v52, v32, -v8
    v_fma_f32 v53, v53, v32, v9
    v_fma_f32 v54, v54, v34, -v10
    v_fma_f32 v55, v55, v34, v11
    ds_write2_b64 v25, v[18:19], v[20:21] offset0:136 offset1:204
    v_cvt_pk_bf16_f32 v22, v52, v53
    v_cvt_pk_bf16_f32 v23, v54, v55
    v_mul_f32 v8, v53, v33
    v_mul_f32 v9, v52, v33
    v_mul_f32 v10, v55, v35
    v_mul_f32 v11, v54, v35
    v_fma_f32 v52, v52, v32, -v8
    v_fma_f32 v53, v53, v32, v9
    v_fma_f32 v54, v54, v34, -v10
    v_fma_f32 v55, v55, v34, v11
    v_cvt_pk_bf16_f32 v16, v52, v53
    v_cvt_pk_bf16_f32 v17, v54, v55
    v_mul_f32 v8, v53, v33
    v_mul_f32 v9, v52, v33
    v_mul_f32 v10, v55, v35
    v_mul_f32 v11, v54, v35
    v_fma_f32 v52, v52, v32, -v8
    v_fma_f32 v53, v53, v32, v9
    v_fma_f32 v54, v54, v34, -v10
    v_fma_f32 v55, v55, v34, v11
    ds_write2_b64 v26, v[22:23], v[16:17] offset0:0 offset1:68
    v_cvt_pk_bf16_f32 v18, v52, v53
    v_cvt_pk_bf16_f32 v19, v54, v55
    v_mul_f32 v8, v53, v33
    v_mul_f32 v9, v52, v33
    v_mul_f32 v10, v55, v35
    v_mul_f32 v11, v54, v35
    v_fma_f32 v52, v52, v32, -v8
    v_fma_f32 v53, v53, v32, v9
    v_fma_f32 v54, v54, v34, -v10
    v_fma_f32 v55, v55, v34, v11
    v_cvt_pk_bf16_f32 v20, v52, v53
    v_cvt_pk_bf16_f32 v21, v54, v55
    v_mul_f32 v8, v53, v33
    v_mul_f32 v9, v52, v33
    v_mul_f32 v10, v55, v35
    v_mul_f32 v11, v54, v35
    v_fma_f32 v52, v52, v32, -v8
    v_fma_f32 v53, v53, v32, v9
    v_fma_f32 v54, v54, v34, -v10
    v_fma_f32 v55, v55, v34, v11
    ds_write2_b64 v26, v[18:19], v[20:21] offset0:136 offset1:204
    v_cvt_pk_bf16_f32 v22, v52, v53
    v_cvt_pk_bf16_f32 v23, v54, v55
    v_mul_f32 v8, v53, v33
    v_mul_f32 v9, v52, v33
    v_mul_f32 v10, v55, v35
    v_mul_f32 v11, v54, v35
    v_fma_f32 v52, v52, v32, -v8
    v_fma_f32 v53, v53, v32, v9
    v_fma_f32 v54, v54, v34, -v10
    v_fma_f32 v55, v55, v34, v11
    v_cvt_pk_bf16_f32 v16, v52, v53
    v_cvt_pk_bf16_f32 v17, v54, v55
    v_mul_f32 v8, v53, v33
    v_mul_f32 v9, v52, v33
    v_mul_f32 v10, v55, v35
    v_mul_f32 v11, v54, v35
    v_fma_f32 v52, v52, v32, -v8
    v_fma_f32 v53, v53, v32, v9
    v_fma_f32 v54, v54, v34, -v10
    v_fma_f32 v55, v55, v34, v11
    ds_write2_b64 v27, v[22:23], v[16:17] offset0:0 offset1:68
    v_cvt_pk_bf16_f32 v18, v52, v53
    v_cvt_pk_bf16_f32 v19, v54, v55
    v_mul_f32 v8, v53, v33
    v_mul_f32 v9, v52, v33
    v_mul_f32 v10, v55, v35
    v_mul_f32 v11, v54, v35
    v_fma_f32 v52, v52, v32, -v8
    v_fma_f32 v53, v53, v32, v9
    v_fma_f32 v54, v54, v34, -v10
    v_fma_f32 v55, v55, v34, v11
    v_cvt_pk_bf16_f32 v20, v52, v53
    v_cvt_pk_bf16_f32 v21, v54, v55
    ds_write2_b64 v27, v[18:19], v[20:21] offset0:136 offset1:204
    ds_read_b128 v[140:143], v3 offset:0
    ds_read_b128 v[144:147], v3 offset:64
    ds_read_b128 v[148:151], v3 offset:128
    ds_read_b128 v[152:155], v3 offset:192
    ds_read_b128 v[156:159], v3 offset:256
    ds_read_b128 v[160:163], v3 offset:320
    ds_read_b128 v[164:167], v3 offset:384
    ds_read_b128 v[168:171], v3 offset:448
    v_mul_f32 v8, v73, v73
    v_mul_f32 v9, v72, v73
    v_mul_f32 v10, v75, v75
    v_mul_f32 v11, v74, v75
    v_fma_f32 v76, v72, v72, -v8
    v_fma_f32 v77, v73, v72, v9
    v_fma_f32 v78, v74, v74, -v10
    v_fma_f32 v79, v75, v74, v11
    v_mul_f32 v8, v61, v73
    v_mul_f32 v9, v60, v73
    v_mul_f32 v10, v63, v75
    v_mul_f32 v11, v62, v75
    v_fma_f32 v52, v60, v72, -v8
    v_fma_f32 v53, v61, v72, v9
    v_fma_f32 v54, v62, v74, -v10
    v_fma_f32 v55, v63, v74, v11
    v_mul_f32 v8, v77, v77
    v_mul_f32 v9, v76, v77
    v_mul_f32 v10, v79, v79
    v_mul_f32 v11, v78, v79
    v_fma_f32 v80, v76, v76, -v8
    v_fma_f32 v81, v77, v76, v9
    v_fma_f32 v82, v78, v78, -v10
    v_fma_f32 v83, v79, v78, v11
    v_mul_f32 v8, v65, v77
    v_mul_f32 v9, v64, v77
    v_mul_f32 v10, v67, v79
    v_mul_f32 v11, v66, v79
    v_fma_f32 v84, v64, v76, -v8
    v_fma_f32 v85, v65, v76, v9
    v_fma_f32 v86, v66, v78, -v10
    v_fma_f32 v87, v67, v78, v11
    v_cvt_pk_bf16_f32 v22, v52, v53
    v_cvt_pk_bf16_f32 v23, v54, v55
    v_mul_f32 v8, v53, v37
    v_mul_f32 v9, v52, v37
    v_mul_f32 v10, v55, v39
    v_mul_f32 v11, v54, v39
    v_fma_f32 v52, v52, v36, -v8
    v_fma_f32 v53, v53, v36, v9
    v_fma_f32 v54, v54, v38, -v10
    v_fma_f32 v55, v55, v38, v11
    v_cvt_pk_bf16_f32 v16, v52, v53
    v_cvt_pk_bf16_f32 v17, v54, v55
    v_mul_f32 v8, v53, v37
    v_mul_f32 v9, v52, v37
    v_mul_f32 v10, v55, v39
    v_mul_f32 v11, v54, v39
    v_fma_f32 v52, v52, v36, -v8
    v_fma_f32 v53, v53, v36, v9
    v_fma_f32 v54, v54, v38, -v10
    v_fma_f32 v55, v55, v38, v11
    ds_write2_b64 v24, v[22:23], v[16:17] offset0:0 offset1:68
    v_cvt_pk_bf16_f32 v18, v52, v53
    v_cvt_pk_bf16_f32 v19, v54, v55
    v_mul_f32 v8, v53, v37
    v_mul_f32 v9, v52, v37
    v_mul_f32 v10, v55, v39
    v_mul_f32 v11, v54, v39
    v_fma_f32 v52, v52, v36, -v8
    v_fma_f32 v53, v53, v36, v9
    v_fma_f32 v54, v54, v38, -v10
    v_fma_f32 v55, v55, v38, v11
    v_cvt_pk_bf16_f32 v20, v52, v53
    v_cvt_pk_bf16_f32 v21, v54, v55
    v_mul_f32 v8, v53, v37
    v_mul_f32 v9, v52, v37
    v_mul_f32 v10, v55, v39
    v_mul_f32 v11, v54, v39
    v_fma_f32 v52, v52, v36, -v8
    v_fma_f32 v53, v53, v36, v9
    v_fma_f32 v54, v54, v38, -v10
    v_fma_f32 v55, v55, v38, v11
    ds_write2_b64 v24, v[18:19], v[20:21] offset0:136 offset1:204
    v_cvt_pk_bf16_f32 v22, v52, v53
    v_cvt_pk_bf16_f32 v23, v54, v55
    v_mul_f32 v8, v53, v37
    v_mul_f32 v9, v52, v37
    v_mul_f32 v10, v55, v39
    v_mul_f32 v11, v54, v39
    v_fma_f32 v52, v52, v36, -v8
    v_fma_f32 v53, v53, v36, v9
    v_fma_f32 v54, v54, v38, -v10
    v_fma_f32 v55, v55, v38, v11
    v_cvt_pk_bf16_f32 v16, v52, v53
    v_cvt_pk_bf16_f32 v17, v54, v55
    v_mul_f32 v8, v53, v37
    v_mul_f32 v9, v52, v37
    v_mul_f32 v10, v55, v39
    v_mul_f32 v11, v54, v39
    v_fma_f32 v52, v52, v36, -v8
    v_fma_f32 v53, v53, v36, v9
    v_fma_f32 v54, v54, v38, -v10
    v_fma_f32 v55, v55, v38, v11
    ds_write2_b64 v25, v[22:23], v[16:17] offset0:0 offset1:68
    v_cvt_pk_bf16_f32 v18, v52, v53
    v_cvt_pk_bf16_f32 v19, v54, v55
    v_mul_f32 v8, v53, v37
    v_mul_f32 v9, v52, v37
    v_mul_f32 v10, v55, v39
    v_mul_f32 v11, v54, v39
    v_fma_f32 v52, v52, v36, -v8
    v_fma_f32 v53, v53, v36, v9
    v_fma_f32 v54, v54, v38, -v10
    v_fma_f32 v55, v55, v38, v11
    v_cvt_pk_bf16_f32 v20, v52, v53
    v_cvt_pk_bf16_f32 v21, v54, v55
    ds_write2_b64 v25, v[18:19], v[20:21] offset0:136 offset1:204
    s_waitcnt lgkmcnt(4)
    v_mfma_f32_16x16x32_bf16 v[92:95], v[140:143], v[108:111], 0
    v_mfma_f32_16x16x32_bf16 v[92:95], v[144:147], v[112:115], v[92:95]
    v_mfma_f32_16x16x32_bf16 v[92:95], v[148:151], v[116:119], v[92:95]
    v_mfma_f32_16x16x32_bf16 v[92:95], v[152:155], v[120:123], v[92:95]
    v_mfma_f32_16x16x32_bf16 v[92:95], v[156:159], v[124:127], v[92:95]
    v_mfma_f32_16x16x32_bf16 v[92:95], v[160:163], v[128:131], v[92:95]
    v_mfma_f32_16x16x32_bf16 v[92:95], v[164:167], v[132:135], v[92:95]
    v_mfma_f32_16x16x32_bf16 v[92:95], v[168:171], v[136:139], v[92:95]
    v_mul_f32 v8, v85, v73
    v_mul_f32 v9, v84, v73
    v_mul_f32 v10, v87, v75
    v_mul_f32 v11, v86, v75
    v_fma_f32 v52, v84, v72, -v8
    v_fma_f32 v53, v85, v72, v9
    v_fma_f32 v54, v86, v74, -v10
    v_fma_f32 v55, v87, v74, v11
    v_cvt_pk_bf16_f32 v22, v84, v85
    v_cvt_pk_bf16_f32 v23, v86, v87
    v_mul_f32 v8, v85, v41
    v_mul_f32 v9, v84, v41
    v_mul_f32 v10, v87, v43
    v_mul_f32 v11, v86, v43
    v_fma_f32 v84, v84, v40, -v8
    v_fma_f32 v85, v85, v40, v9
    v_fma_f32 v86, v86, v42, -v10
    v_fma_f32 v87, v87, v42, v11
    v_cvt_pk_bf16_f32 v16, v84, v85
    v_cvt_pk_bf16_f32 v17, v86, v87
    v_mul_f32 v8, v85, v41
    v_mul_f32 v9, v84, v41
    v_mul_f32 v10, v87, v43
    v_mul_f32 v11, v86, v43
    v_fma_f32 v84, v84, v40, -v8
    v_fma_f32 v85, v85, v40, v9
    v_fma_f32 v86, v86, v42, -v10
    v_fma_f32 v87, v87, v42, v11
    ds_write2_b64 v26, v[22:23], v[16:17] offset0:0 offset1:68
    v_cvt_pk_bf16_f32 v18, v84, v85
    v_cvt_pk_bf16_f32 v19, v86, v87
    v_mul_f32 v8, v85, v41
    v_mul_f32 v9, v84, v41
    v_mul_f32 v10, v87, v43
    v_mul_f32 v11, v86, v43
    v_fma_f32 v84, v84, v40, -v8
    v_fma_f32 v85, v85, v40, v9
    v_fma_f32 v86, v86, v42, -v10
    v_fma_f32 v87, v87, v42, v11
    v_cvt_pk_bf16_f32 v20, v84, v85
    v_cvt_pk_bf16_f32 v21, v86, v87
    ds_write2_b64 v26, v[18:19], v[20:21] offset0:136 offset1:204
    v_cvt_pk_bf16_f32 v22, v52, v53
    v_cvt_pk_bf16_f32 v23, v54, v55
    v_mul_f32 v8, v53, v41
    v_mul_f32 v9, v52, v41
    v_mul_f32 v10, v55, v43
    v_mul_f32 v11, v54, v43
    v_fma_f32 v52, v52, v40, -v8
    v_fma_f32 v53, v53, v40, v9
    v_fma_f32 v54, v54, v42, -v10
    v_fma_f32 v55, v55, v42, v11
    v_cvt_pk_bf16_f32 v16, v52, v53
    v_cvt_pk_bf16_f32 v17, v54, v55
    v_mul_f32 v8, v53, v41
    v_mul_f32 v9, v52, v41
    v_mul_f32 v10, v55, v43
    v_mul_f32 v11, v54, v43
    v_fma_f32 v52, v52, v40, -v8
    v_fma_f32 v53, v53, v40, v9
    v_fma_f32 v54, v54, v42, -v10
    v_fma_f32 v55, v55, v42, v11
    ds_write2_b64 v27, v[22:23], v[16:17] offset0:0 offset1:68
    v_cvt_pk_bf16_f32 v18, v52, v53
    v_cvt_pk_bf16_f32 v19, v54, v55
    v_mul_f32 v8, v53, v41
    v_mul_f32 v9, v52, v41
    v_mul_f32 v10, v55, v43
    v_mul_f32 v11, v54, v43
    v_fma_f32 v52, v52, v40, -v8
    v_fma_f32 v53, v53, v40, v9
    v_fma_f32 v54, v54, v42, -v10
    v_fma_f32 v55, v55, v42, v11
    v_cvt_pk_bf16_f32 v20, v52, v53
    v_cvt_pk_bf16_f32 v21, v54, v55
    ds_write2_b64 v27, v[18:19], v[20:21] offset0:136 offset1:204
    ds_read_b128 v[172:175], v3 offset:0
    ds_read_b128 v[176:179], v3 offset:64
    ds_read_b128 v[180:183], v3 offset:128
    ds_read_b128 v[184:187], v3 offset:192
    ds_read_b128 v[188:191], v3 offset:256
    ds_read_b128 v[192:195], v3 offset:320
    ds_read_b128 v[196:199], v3 offset:384
    ds_read_b128 v[200:203], v3 offset:448
    v_mul_f32 v8, v69, v81
    v_mul_f32 v9, v68, v81
    v_mul_f32 v10, v71, v83
    v_mul_f32 v11, v70, v83
    v_fma_f32 v52, v68, v80, -v8
    v_fma_f32 v53, v69, v80, v9
    v_fma_f32 v54, v70, v82, -v10
    v_fma_f32 v55, v71, v82, v11
    v_mul_f32 v8, v53, v45
    v_mul_f32 v9, v52, v45
    v_mul_f32 v10, v55, v47
    v_mul_f32 v11, v54, v47
    v_fma_f32 v84, v52, v44, -v8
    v_fma_f32 v85, v53, v44, v9
    v_fma_f32 v86, v54, v46, -v10
    v_fma_f32 v87, v55, v46, v11
    v_mov_b32 v2, s80
    global_load_dword v237, v2, s[44:45] sc1
    v_cvt_pk_bf16_f32 v16, v52, v53
    v_cvt_pk_bf16_f32 v17, v54, v55
    v_cvt_pk_bf16_f32 v18, v84, v85
    v_cvt_pk_bf16_f32 v19, v86, v87
    v_mul_f32 v8, v53, v73
    v_mul_f32 v9, v52, v73
    v_mul_f32 v10, v55, v75
    v_mul_f32 v11, v54, v75
    v_mul_f32 v12, v85, v73
    v_mul_f32 v13, v84, v73
    v_mul_f32 v14, v87, v75
    v_mul_f32 v15, v86, v75
    v_fma_f32 v52, v52, v72, -v8
    v_fma_f32 v53, v53, v72, v9
    v_fma_f32 v54, v54, v74, -v10
    v_fma_f32 v55, v55, v74, v11
    v_fma_f32 v84, v84, v72, -v12
    v_fma_f32 v85, v85, v72, v13
    v_fma_f32 v86, v86, v74, -v14
    v_fma_f32 v87, v87, v74, v15
    ds_write2_b64 v24, v[16:17], v[18:19] offset0:0 offset1:68
    v_cvt_pk_bf16_f32 v20, v52, v53
    v_cvt_pk_bf16_f32 v21, v54, v55
    v_cvt_pk_bf16_f32 v22, v84, v85
    v_cvt_pk_bf16_f32 v23, v86, v87
    v_mul_f32 v8, v53, v73
    v_mul_f32 v9, v52, v73
    v_mul_f32 v10, v55, v75
    v_mul_f32 v11, v54, v75
    v_mul_f32 v12, v85, v73
    v_mul_f32 v13, v84, v73
    v_mul_f32 v14, v87, v75
    v_mul_f32 v15, v86, v75
    v_fma_f32 v52, v52, v72, -v8
    v_fma_f32 v53, v53, v72, v9
    v_fma_f32 v54, v54, v74, -v10
    v_fma_f32 v55, v55, v74, v11
    v_fma_f32 v84, v84, v72, -v12
    v_fma_f32 v85, v85, v72, v13
    v_fma_f32 v86, v86, v74, -v14
    v_fma_f32 v87, v87, v74, v15
    ds_write2_b64 v24, v[20:21], v[22:23] offset0:136 offset1:204
    v_cvt_pk_bf16_f32 v16, v52, v53
    v_cvt_pk_bf16_f32 v17, v54, v55
    v_cvt_pk_bf16_f32 v18, v84, v85
    v_cvt_pk_bf16_f32 v19, v86, v87
    v_mul_f32 v8, v53, v73
    v_mul_f32 v9, v52, v73
    v_mul_f32 v10, v55, v75
    v_mul_f32 v11, v54, v75
    v_mul_f32 v12, v85, v73
    v_mul_f32 v13, v84, v73
    v_mul_f32 v14, v87, v75
    v_mul_f32 v15, v86, v75
    v_fma_f32 v52, v52, v72, -v8
    v_fma_f32 v53, v53, v72, v9
    v_fma_f32 v54, v54, v74, -v10
    v_fma_f32 v55, v55, v74, v11
    v_fma_f32 v84, v84, v72, -v12
    v_fma_f32 v85, v85, v72, v13
    v_fma_f32 v86, v86, v74, -v14
    v_fma_f32 v87, v87, v74, v15
    ds_write2_b64 v25, v[16:17], v[18:19] offset0:0 offset1:68
    v_cvt_pk_bf16_f32 v20, v52, v53
    v_cvt_pk_bf16_f32 v21, v54, v55
    v_cvt_pk_bf16_f32 v22, v84, v85
    v_cvt_pk_bf16_f32 v23, v86, v87
    ds_write2_b64 v25, v[20:21], v[22:23] offset0:136 offset1:204
    v_cvt_pk_bf16_f32 v16, v56, v57
    v_cvt_pk_bf16_f32 v17, v58, v59
    ds_write_b64 v24, v[16:17] offset:4352
    ds_read_b128 v[140:143], v3 offset:0
    ds_read_b128 v[144:147], v3 offset:64
    ds_read_b128 v[148:151], v3 offset:128
    ds_read_b128 v[152:155], v3 offset:192
    ds_read_b128 v[156:159], v3 offset:256
    ds_read_b128 v[160:163], v3 offset:320
    ds_read_b128 v[164:167], v3 offset:384
    ds_read_b128 v[168:171], v3 offset:448
    s_waitcnt lgkmcnt(8)
    v_mfma_f32_16x16x32_bf16 v[96:99], v[172:175], v[108:111], 0
    v_mfma_f32_16x16x32_bf16 v[96:99], v[176:179], v[112:115], v[96:99]
    v_mfma_f32_16x16x32_bf16 v[96:99], v[180:183], v[116:119], v[96:99]
    v_mfma_f32_16x16x32_bf16 v[96:99], v[184:187], v[120:123], v[96:99]
    v_mfma_f32_16x16x32_bf16 v[96:99], v[188:191], v[124:127], v[96:99]
    v_mfma_f32_16x16x32_bf16 v[96:99], v[192:195], v[128:131], v[96:99]
    v_mfma_f32_16x16x32_bf16 v[96:99], v[196:199], v[132:135], v[96:99]
    v_mfma_f32_16x16x32_bf16 v[96:99], v[200:203], v[136:139], v[96:99]
    s_waitcnt lgkmcnt(0)
    v_mfma_f32_16x16x32_bf16 v[100:103], v[140:143], v[108:111], 0
    v_mfma_f32_16x16x32_bf16 v[100:103], v[144:147], v[112:115], v[100:103]
    v_mfma_f32_16x16x32_bf16 v[100:103], v[148:151], v[116:119], v[100:103]
    v_mfma_f32_16x16x32_bf16 v[100:103], v[152:155], v[120:123], v[100:103]
    v_mfma_f32_16x16x32_bf16 v[100:103], v[156:159], v[124:127], v[100:103]
    v_mfma_f32_16x16x32_bf16 v[100:103], v[160:163], v[128:131], v[100:103]
    v_mfma_f32_16x16x32_bf16 v[100:103], v[164:167], v[132:135], v[100:103]
    v_mfma_f32_16x16x32_bf16 v[100:103], v[168:171], v[136:139], v[100:103]
    s_waitcnt vmcnt(0)
    v_cmp_ne_u32 vcc, s47, v237
    s_or_b32 s79, vcc_lo, vcc_hi
    s_cbranch_scc1 KC_NOU
    s_lshl_b32 s10, s72, 12
    s_lshl_b32 s11, s7, 11
    s_add_u32 s10, s10, s11
    s_add_u32 s10, s10, 7340032
    v_lshlrev_b32 v1, 4, v0
    buffer_load_dwordx4 v[172:175], v1, s[56:59], s10 offen sc1
    buffer_load_dwordx4 v[176:179], v1, s[56:59], s10 offen offset:1024 sc1
KC_NOU:
    ds_write_b128 v228, v[92:95]
    ds_write_b128 v229, v[96:99]
    s_mov_b32 exec_lo, -1
    s_mov_b32 exec_hi, 0
    ds_write2_b64 v230, v[100:101], v[102:103] offset0:0 offset1:16
    s_mov_b32 exec_lo, 0
    s_mov_b32 exec_hi, 1
    v_mov_b32 v1, s74
    ds_write_b32 v1, v100
    s_mov_b64 exec, -1
    v_mov_b32 v12, 0
    v_mov_b32 v13, 0
    v_mov_b32 v14, 0
    v_mov_b32 v15, 0
    s_cmp_eq_u32 s7, 0
    s_cbranch_scc1 KC_Z2
    v_lshl_add_u32 v1, v0, 2, s74
    s_mov_b64 exec, 15
    v_subrev_u32 v1, 16, v1
    ds_write_b32 v1, v12
    s_mov_b64 exec, 0x3fffffff
    v_lshl_add_u32 v1, v0, 4, s9
    ds_write_b128 v1, v[12:15] offset:16896
    s_mov_b64 exec, -1
KC_Z2:
    v_mov_b32 v5, 1
    s_waitcnt lgkmcnt(0)
    ds_write_b32 v6, v5
PS_61:
    s_sub_u32 s69, s69, 1
    s_cbranch_scc1 recurrent_scan__ssm_conv_s4d__mixer_channel_mlp__prompt_kernel_BAIL
    ds_read_b32 v5, v7
    s_waitcnt lgkmcnt(0)
    v_cmp_gt_u32 vcc, 1, v5
    s_cbranch_vccnz PS_61
    ds_read2st64_b32 v[32:33], v204 offset0:0 offset1:16
    ds_read2st64_b32 v[34:35], v205 offset0:0 offset1:16
    ds_read2st64_b32 v[36:37], v206 offset0:0 offset1:16
    ds_read2st64_b32 v[38:39], v207 offset0:0 offset1:16
    ds_read2st64_b32 v[40:41], v208 offset0:0 offset1:16
    ds_read2st64_b32 v[42:43], v209 offset0:0 offset1:16
    ds_read2st64_b32 v[44:45], v210 offset0:0 offset1:16
    ds_read2st64_b32 v[46:47], v211 offset0:0 offset1:16
    ds_read2st64_b32 v[48:49], v212 offset0:0 offset1:16
    ds_read2st64_b32 v[50:51], v213 offset0:0 offset1:16
    ds_read2st64_b32 v[52:53], v214 offset0:0 offset1:16
    ds_read2st64_b32 v[54:55], v215 offset0:0 offset1:16
    ds_read2st64_b32 v[56:57], v216 offset0:0 offset1:16
    ds_read2st64_b32 v[58:59], v217 offset0:0 offset1:16
    ds_read2st64_b32 v[60:61], v218 offset0:0 offset1:16
    ds_read2st64_b32 v[62:63], v219 offset0:0 offset1:16
    ds_read2st64_b32 v[64:65], v220 offset0:0 offset1:16
    ds_read2st64_b32 v[66:67], v221 offset0:0 offset1:16
    ds_read2st64_b32 v[68:69], v222 offset0:0 offset1:16
    ds_read2st64_b32 v[70:71], v223 offset0:0 offset1:16
    ds_read2st64_b32 v[72:73], v224 offset0:0 offset1:16
    ds_read2st64_b32 v[74:75], v225 offset0:0 offset1:16
    ds_read2st64_b32 v[76:77], v226 offset0:0 offset1:16
    ds_read2st64_b32 v[78:79], v227 offset0:0 offset1:16
    s_lshl_b32 s10, s7, 11
    s_add_u32 s10, s10, s9
    s_add_u32 s10, s10, 32
    v_lshl_add_u32 v2, v0, 4, s10
    v_add_u32 v3, 8320, v2
    s_waitcnt lgkmcnt(0)
    v_add_f32 v32, v32, v33
    v_add_f32 v34, v34, v35
    v_add_f32 v36, v36, v37
    v_add_f32 v38, v38, v39
    v_add_f32 v40, v40, v41
    v_add_f32 v42, v42, v43
    v_add_f32 v44, v44, v45
    v_add_f32 v46, v46, v47
    v_add_f32 v48, v48, v49
    v_add_f32 v50, v50, v51
    v_add_f32 v52, v52, v53
    v_add_f32 v54, v54, v55
    v_cvt_pk_bf16_f32 v88, v32, v34
    v_cvt_pk_bf16_f32 v84, v36, v38
    v_cvt_pk_bf16_f32 v80, v40, v42
    v_cvt_pk_bf16_f32 v81, v44, v46
    v_cvt_pk_bf16_f32 v82, v48, v50
    v_cvt_pk_bf16_f32 v83, v52, v54
    v_mov_b32 v85, v80
    v_mov_b32 v86, v81
    v_mov_b32 v87, v82
    v_alignbit_b32 v120, v80, v84, 16
    v_alignbit_b32 v121, v81, v80, 16
    v_alignbit_b32 v122, v82, v81, 16
    v_alignbit_b32 v123, v83, v82, 16
    v_alignbit_b32 v124, v84, v88, 16
    v_mov_b32 v125, v120
    v_mov_b32 v126, v121
    v_mov_b32 v127, v122
    ds_write_b128 v2, v[80:83] offset:0
    ds_write_b128 v2, v[120:123] offset:4160
    ds_write_b128 v3, v[84:87] offset:0
    ds_write_b128 v3, v[124:127] offset:4160
    v_add_f32 v56, v56, v57
    v_add_f32 v58, v58, v59
    v_add_f32 v60, v60, v61
    v_add_f32 v62, v62, v63
    v_add_f32 v64, v64, v65
    v_add_f32 v66, v66, v67
    v_add_f32 v68, v68, v69
    v_add_f32 v70, v70, v71
    v_add_f32 v72, v72, v73
    v_add_f32 v74, v74, v75
    v_add_f32 v76, v76, v77
    v_add_f32 v78, v78, v79
    v_cvt_pk_bf16_f32 v104, v56, v58
    v_cvt_pk_bf16_f32 v100, v60, v62
    v_cvt_pk_bf16_f32 v96, v64, v66
    v_cvt_pk_bf16_f32 v97, v68, v70
    v_cvt_pk_bf16_f32 v98, v72, v74
    v_cvt_pk_bf16_f32 v99, v76, v78
    v_mov_b32 v101, v96
    v_mov_b32 v102, v97
    v_mov_b32 v103, v98
    v_alignbit_b32 v120, v96, v100, 16
    v_alignbit_b32 v121, v97, v96, 16
    v_alignbit_b32 v122, v98, v97, 16
    v_alignbit_b32 v123, v99, v98, 16
    v_alignbit_b32 v124, v100, v104, 16
    v_mov_b32 v125, v120
    v_mov_b32 v126, v121
    v_mov_b32 v127, v122
    ds_write_b128 v2, v[96:99] offset:1024
    ds_write_b128 v2, v[120:123] offset:5184
    ds_write_b128 v3, v[100:103] offset:1024
    ds_write_b128 v3, v[124:127] offset:5184
    s_cmp_lg_u32 s7, 0
    s_cbranch_scc1 KC_Z3
    v_lshrrev_b32 v1, 1, v0
    v_mul_u32_u24 v1, 4160, v1
    v_and_b32 v4, 1, v0
    v_lshl_add_u32 v1, v4, 4, v1
    v_add_u32 v1, s9, v1
    v_mov_b32 v12, 0
    v_mov_b32 v13, 0
    v_mov_b32 v14, 0
    v_mov_b32 v15, 0
    s_mov_b64 exec, 0xff
    ds_write_b128 v1, v[12:15]
    s_mov_b64 exec, -1
KC_Z3:
    v_mov_b32 v5, 2
    s_waitcnt lgkmcnt(0)
    ds_write_b32 v6, v5
PS_62:
    s_sub_u32 s69, s69, 1
    s_cbranch_scc1 recurrent_scan__ssm_conv_s4d__mixer_channel_mlp__prompt_kernel_BAIL
    ds_read_b32 v5, v7
    s_waitcnt lgkmcnt(0)
    v_cmp_gt_u32 vcc, 2, v5
    s_cbranch_vccnz PS_62
    s_cmp_lg_u32 s79, 0
    s_cbranch_scc1 KC_LNS
KC_HAVEU:
    s_lshl_b32 s10, s7, 11
    s_add_u32 s10, s10, s9
    v_lshl_add_u32 v1, v0, 4, s10
    s_waitcnt vmcnt(0)
    ds_write_b128 v1, v[172:175] offset:17376
    ds_write_b128 v1, v[176:179] offset:18400
    v_lshrrev_b32 v4, 4, v0
    v_bfe_u32 v8, v0, 2, 2
    v_mul_u32_u24 v8, 4160, v8
    v_and_b32 v9, 3, v0
    v_lshl_add_u32 v8, v9, 3, v8
    v_lshrrev_b32 v9, 1, v4
    v_and_b32 v10, 1, v4
    v_lshlrev_b32 v11, 5, v9
    v_lshlrev_b32 v12, 4, v10
    v_add_u32 v8, v8, v11
    v_sub_u32 v8, v8, v12
    s_lshl_b32 s10, s7, 8
    s_add_u32 s14, s10, s9
    s_add_u32 s14, s14, 24
    v_add_u32 v2, s14, v8
    v_and_b32 v8, 15, v0
    v_lshlrev_b32 v8, 5, v8
    v_sub_u32 v8, v8, v11
    v_add_u32 v8, v8, v12
    s_sub_u32 s14, s9, s10
    s_add_u32 s14, s14, 17376
    v_add_u32 v3, s14, v8
    v_mov_b32 v80, 0
    v_mov_b32 v81, 0
    v_mov_b32 v82, 0
    v_mov_b32 v83, 0
    v_mov_b32 v84, 0
    v_mov_b32 v85, 0
    v_mov_b32 v86, 0
    v_mov_b32 v87, 0
    v_mov_b32 v88, 0
    v_mov_b32 v89, 0
    v_mov_b32 v90, 0
    v_mov_b32 v91, 0
    v_mov_b32 v92, 0
    v_mov_b32 v93, 0
    v_mov_b32 v94, 0
    v_mov_b32 v95, 0
    v_mov_b32 v96, 0
    v_mov_b32 v97, 0
    v_mov_b32 v98, 0
    v_mov_b32 v99, 0
    v_mov_b32 v100, 0
    v_mov_b32 v101, 0
    v_mov_b32 v102, 0
    v_mov_b32 v103, 0
    v_mov_b32 v104, 0
    v_mov_b32 v105, 0
    v_mov_b32 v106, 0
    v_mov_b32 v107, 0
    v_mov_b32 v108, 0
    v_mov_b32 v109, 0
    v_mov_b32 v110, 0
    v_mov_b32 v111, 0
    v_mov_b32 v5, 3
    s_waitcnt lgkmcnt(0)
    ds_write_b32 v6, v5
PS_63:
    s_sub_u32 s69, s69, 1
    s_cbranch_scc1 recurrent_scan__ssm_conv_s4d__mixer_channel_mlp__prompt_kernel_BAIL
    ds_read_b32 v5, v7
    s_waitcnt lgkmcnt(0)
    v_cmp_gt_u32 vcc, 3, v5
    s_cbranch_vccnz PS_63
    s_setprio 3
    ds_read_b128 v[60:63], v3 offset:3584
    ds_read_b128 v[56:59], v3 offset:3072
    ds_read_b128 v[52:55], v3 offset:2560
    ds_read_b128 v[48:51], v3 offset:2048
    ds_read_b128 v[44:47], v3 offset:1536
    ds_read_b128 v[40:43], v3 offset:1024
    ds_read_b128 v[36:39], v3 offset:512
    ds_read_b128 v[32:35], v3 offset:0
    ds_read_b64_tr_b16 v[64:65], v2 offset:8
    ds_read_b64_tr_b16 v[66:67], v2 offset:0
    ds_read_b64_tr_b16 v[68:69], v2 offset:520
    ds_read_b64_tr_b16 v[70:71], v2 offset:512
    ds_read_b64_tr_b16 v[72:73], v2 offset:1032
    ds_read_b64_tr_b16 v[74:75], v2 offset:1024
    v_subrev_u32 v3, 64, v3
    s_mov_b32 s10, 4
    s_waitcnt lgkmcnt(0)
CONV_LOOP:
    s_waitcnt lgkmcnt(7)
    ds_read_b64_tr_b16 v[76:77], v2 offset:1544
    ds_read_b64_tr_b16 v[78:79], v2 offset:1536
    v_mfma_f32_16x16x32_bf16 v[108:111], v[64:67], v[60:63], v[108:111]
    ds_read_b128 v[60:63], v3 offset:3584
    v_mfma_f32_16x16x32_bf16 v[104:107], v[64:67], v[56:59], v[104:107]
    v_mfma_f32_16x16x32_bf16 v[100:103], v[64:67], v[52:55], v[100:103]
    v_mfma_f32_16x16x32_bf16 v[96:99], v[64:67], v[48:51], v[96:99]
    v_mfma_f32_16x16x32_bf16 v[92:95], v[64:67], v[44:47], v[92:95]
    s_waitcnt lgkmcnt(9)
    v_mfma_f32_16x16x32_bf16 v[88:91], v[64:67], v[40:43], v[88:91]
    s_waitcnt lgkmcnt(6)
    v_mfma_f32_16x16x32_bf16 v[84:87], v[64:67], v[36:39], v[84:87]
    s_waitcnt lgkmcnt(3)
    v_mfma_f32_16x16x32_bf16 v[80:83], v[64:67], v[32:35], v[80:83]
    s_waitcnt lgkmcnt(7)
    ds_read_b64_tr_b16 v[64:65], v2 offset:2056
    ds_read_b64_tr_b16 v[66:67], v2 offset:2048
    v_mfma_f32_16x16x32_bf16 v[108:111], v[68:71], v[56:59], v[108:111]
    ds_read_b128 v[56:59], v3 offset:3072
    v_mfma_f32_16x16x32_bf16 v[104:107], v[68:71], v[52:55], v[104:107]
    v_mfma_f32_16x16x32_bf16 v[100:103], v[68:71], v[48:51], v[100:103]
    v_mfma_f32_16x16x32_bf16 v[96:99], v[68:71], v[44:47], v[96:99]
    v_mfma_f32_16x16x32_bf16 v[92:95], v[68:71], v[40:43], v[92:95]
    v_mfma_f32_16x16x32_bf16 v[88:91], v[68:71], v[36:39], v[88:91]
    v_mfma_f32_16x16x32_bf16 v[84:87], v[68:71], v[32:35], v[84:87]
    s_waitcnt lgkmcnt(7)
    ds_read_b64_tr_b16 v[68:69], v2 offset:2568
    ds_read_b64_tr_b16 v[70:71], v2 offset:2560
    v_mfma_f32_16x16x32_bf16 v[108:111], v[72:75], v[52:55], v[108:111]
    ds_read_b128 v[52:55], v3 offset:2560
    v_mfma_f32_16x16x32_bf16 v[104:107], v[72:75], v[48:51], v[104:107]
    v_mfma_f32_16x16x32_bf16 v[100:103], v[72:75], v[44:47], v[100:103]
    v_mfma_f32_16x16x32_bf16 v[96:99], v[72:75], v[40:43], v[96:99]
    v_mfma_f32_16x16x32_bf16 v[92:95], v[72:75], v[36:39], v[92:95]
    v_mfma_f32_16x16x32_bf16 v[88:91], v[72:75], v[32:35], v[88:91]
    s_waitcnt lgkmcnt(7)
    ds_read_b64_tr_b16 v[72:73], v2 offset:3080
    ds_read_b64_tr_b16 v[74:75], v2 offset:3072
    v_mfma_f32_16x16x32_bf16 v[108:111], v[76:79], v[48:51], v[108:111]
    ds_read_b128 v[48:51], v3 offset:2048
    v_mfma_f32_16x16x32_bf16 v[104:107], v[76:79], v[44:47], v[104:107]
    v_mfma_f32_16x16x32_bf16 v[100:103], v[76:79], v[40:43], v[100:103]
    v_mfma_f32_16x16x32_bf16 v[96:99], v[76:79], v[36:39], v[96:99]
    v_mfma_f32_16x16x32_bf16 v[92:95], v[76:79], v[32:35], v[92:95]
    s_waitcnt lgkmcnt(7)
    ds_read_b64_tr_b16 v[76:77], v2 offset:3592
    ds_read_b64_tr_b16 v[78:79], v2 offset:3584
    v_mfma_f32_16x16x32_bf16 v[108:111], v[64:67], v[44:47], v[108:111]
    ds_read_b128 v[44:47], v3 offset:1536
    v_mfma_f32_16x16x32_bf16 v[104:107], v[64:67], v[40:43], v[104:107]
    v_mfma_f32_16x16x32_bf16 v[100:103], v[64:67], v[36:39], v[100:103]
    v_mfma_f32_16x16x32_bf16 v[96:99], v[64:67], v[32:35], v[96:99]
    s_waitcnt lgkmcnt(7)
    ds_read_b64_tr_b16 v[64:65], v2 offset:72
    ds_read_b64_tr_b16 v[66:67], v2 offset:64
    v_mfma_f32_16x16x32_bf16 v[108:111], v[68:71], v[40:43], v[108:111]
    ds_read_b128 v[40:43], v3 offset:1024
    v_mfma_f32_16x16x32_bf16 v[104:107], v[68:71], v[36:39], v[104:107]
    v_mfma_f32_16x16x32_bf16 v[100:103], v[68:71], v[32:35], v[100:103]
    s_waitcnt lgkmcnt(7)
    ds_read_b64_tr_b16 v[68:69], v2 offset:584
    ds_read_b64_tr_b16 v[70:71], v2 offset:576
    v_mfma_f32_16x16x32_bf16 v[108:111], v[72:75], v[36:39], v[108:111]
    ds_read_b128 v[36:39], v3 offset:512
    v_mfma_f32_16x16x32_bf16 v[104:107], v[72:75], v[32:35], v[104:107]
    s_waitcnt lgkmcnt(7)
    ds_read_b64_tr_b16 v[72:73], v2 offset:1096
    ds_read_b64_tr_b16 v[74:75], v2 offset:1088
    v_mfma_f32_16x16x32_bf16 v[108:111], v[76:79], v[32:35], v[108:111]
    ds_read_b128 v[32:35], v3 offset:0
    v_add_u32 v2, 64, v2
    v_subrev_u32 v3, 64, v3
    s_sub_u32 s10, s10, 1
    s_cmp_lg_u32 s10, 0
    s_cbranch_scc1 CONV_LOOP
    v_mov_b32 v5, 4
    s_waitcnt lgkmcnt(0)
    ds_write_b32 v6, v5
PS_64:
    s_sub_u32 s69, s69, 1
    s_cbranch_scc1 recurrent_scan__ssm_conv_s4d__mixer_channel_mlp__prompt_kernel_BAIL
    ds_read_b32 v5, v7
    s_waitcnt lgkmcnt(0)
    v_cmp_gt_u32 vcc, 4, v5
    s_cbranch_vccnz PS_64
    s_lshl_b32 s10, s7, 12
    s_add_u32 s10, s10, s9
    v_lshl_add_u32 v2, v0, 4, s10
    v_xor_b32 v3, 4096, v2
    s_cmp_lg_u32 s7, 0
    s_cbranch_scc1 KC_X1
    ds_write_b128 v2, v[96:99] offset:0
    ds_write_b128 v2, v[100:103] offset:1024
    ds_write_b128 v2, v[104:107] offset:2048
    ds_write_b128 v2, v[108:111] offset:3072
    s_branch KC_X2
KC_X1:
    ds_write_b128 v2, v[80:83] offset:0
    ds_write_b128 v2, v[84:87] offset:1024
    ds_write_b128 v2, v[88:91] offset:2048
    ds_write_b128 v2, v[92:95] offset:3072
    v_mov_b64 v[80:81], v[96:97]
    v_mov_b64 v[82:83], v[98:99]
    v_mov_b64 v[84:85], v[100:101]
    v_mov_b64 v[86:87], v[102:103]
    v_mov_b64 v[88:89], v[104:105]
    v_mov_b64 v[90:91], v[106:107]
    v_mov_b64 v[92:93], v[108:109]
    v_mov_b64 v[94:95], v[110:111]
KC_X2:
    v_and_b32 v8, 15, v0
    v_lshlrev_b32 v8, 5, v8
    v_lshrrev_b32 v4, 4, v0
    v_lshl_add_u32 v8, v4, 3, v8
    s_lshl_b32 s10, s7, 11
    v_add_u32 v8, s10, v8
    s_add_u32 s14, s9, 17376
    v_add_u32 v9, s14, v8
    ds_read_b64 v[48:49], v9 offset:0
    ds_read_b64 v[50:51], v9 offset:512
    ds_read_b64 v[52:53], v9 offset:1024
    ds_read_b64 v[54:55], v9 offset:1536
    v_mov_b32 v5, 5
    s_waitcnt lgkmcnt(0)
    ds_write_b32 v6, v5
PS_65:
    s_sub_u32 s69, s69, 1
    s_cbranch_scc1 recurrent_scan__ssm_conv_s4d__mixer_channel_mlp__prompt_kernel_BAIL
    ds_read_b32 v5, v7
    s_waitcnt lgkmcnt(0)
    v_cmp_gt_u32 vcc, 5, v5
    s_cbranch_vccnz PS_65
    ds_read_b128 v[32:35], v3 offset:0
    ds_read_b128 v[36:39], v3 offset:1024
    ds_read_b128 v[40:43], v3 offset:2048
    ds_read_b128 v[44:47], v3 offset:3072
    s_lshl_b32 s10, s72, 12
    s_add_u32 s10, s10, 9175040
    v_mov_b32 v10, s77
    v_mov_b32 v11, s77
    v_lshlrev_b32 v12, 16, v48
    v_and_b32 v13, 0xffff0000, v48
    v_lshlrev_b32 v14, 16, v49
    v_and_b32 v15, 0xffff0000, v49
    v_fmac_f32 v80, v12, v10
    v_fmac_f32 v81, v13, v10
    v_fmac_f32 v82, v14, v10
    v_fmac_f32 v83, v15, v10
    s_waitcnt lgkmcnt(3)
    v_add_f32 v80, v80, v32
    v_add_f32 v81, v81, v33
    v_add_f32 v82, v82, v34
    v_add_f32 v83, v83, v35
    v_cvt_pk_bf16_f32 v24, v80, v81
    v_cvt_pk_bf16_f32 v25, v82, v83
    buffer_store_dwordx2 v[24:25], v8, s[56:59], s10 offen offset:0 sc1
    v_lshlrev_b32 v12, 16, v50
    v_and_b32 v13, 0xffff0000, v50
    v_lshlrev_b32 v14, 16, v51
    v_and_b32 v15, 0xffff0000, v51
    v_fmac_f32 v84, v12, v10
    v_fmac_f32 v85, v13, v10
    v_fmac_f32 v86, v14, v10
    v_fmac_f32 v87, v15, v10
    s_waitcnt lgkmcnt(2)
    v_add_f32 v84, v84, v36
    v_add_f32 v85, v85, v37
    v_add_f32 v86, v86, v38
    v_add_f32 v87, v87, v39
    v_cvt_pk_bf16_f32 v26, v84, v85
    v_cvt_pk_bf16_f32 v27, v86, v87
    buffer_store_dwordx2 v[26:27], v8, s[56:59], s10 offen offset:512 sc1
    v_lshlrev_b32 v12, 16, v52
    v_and_b32 v13, 0xffff0000, v52
    v_lshlrev_b32 v14, 16, v53
    v_and_b32 v15, 0xffff0000, v53
    v_fmac_f32 v88, v12, v10
    v_fmac_f32 v89, v13, v10
    v_fmac_f32 v90, v14, v10
    v_fmac_f32 v91, v15, v10
    s_waitcnt lgkmcnt(1)
    v_add_f32 v88, v88, v40
    v_add_f32 v89, v89, v41
    v_add_f32 v90, v90, v42
    v_add_f32 v91, v91, v43
    v_cvt_pk_bf16_f32 v24, v88, v89
    v_cvt_pk_bf16_f32 v25, v90, v91
    buffer_store_dwordx2 v[24:25], v8, s[56:59], s10 offen offset:1024 sc1
    v_lshlrev_b32 v12, 16, v54
    v_and_b32 v13, 0xffff0000, v54
    v_lshlrev_b32 v14, 16, v55
    v_and_b32 v15, 0xffff0000, v55
    v_fmac_f32 v92, v12, v10
    v_fmac_f32 v93, v13, v10
    v_fmac_f32 v94, v14, v10
    v_fmac_f32 v95, v15, v10
    s_waitcnt lgkmcnt(0)
    v_add_f32 v92, v92, v44
    v_add_f32 v93, v93, v45
    v_add_f32 v94, v94, v46
    v_add_f32 v95, v95, v47
    v_cvt_pk_bf16_f32 v26, v92, v93
    v_cvt_pk_bf16_f32 v27, v94, v95
    buffer_store_dwordx2 v[26:27], v8, s[56:59], s10 offen offset:1536 sc1
    s_lshr_b32 s10, s70, 5
    s_lshl_b32 s11, s10, 10
    s_add_u32 s11, s11, 11067392
    s_lshl_b32 s10, s10, 7
    s_add_u32 s10, s10, 11063296
    s_waitcnt vmcnt(0)
    v_mov_b32 v8, 138776
    v_mov_b32 v9, 1
    s_mov_b64 exec, 1
    ds_add_rtn_u32 v9, v8, v9
    s_waitcnt lgkmcnt(0)
    v_cmp_eq_u32 vcc, 3, v9
    s_cbranch_vccz PUB_66
    v_mov_b32 v8, s10
    v_mov_b32 v9, 1
    global_atomic_add v9, v8, v9, s[44:45] sc0
    s_waitcnt vmcnt(0)
    v_and_b32 v9, 31, v9
    v_cmp_eq_u32 vcc, 31, v9
    s_cbranch_vccz PUB_66
    s_mov_b64 exec, 0xff
    v_mbcnt_lo_u32_b32 v8, -1, 0
    v_lshl_add_u32 v8, v8, 7, s11
    v_mov_b32 v9, s47
    global_store_dword v8, v9, s[44:45] sc1
PUB_66:
    s_mov_b64 exec, -1
    s_branch recurrent_scan__ssm_conv_s4d__mixer_channel_mlp__prompt_kernel_END
R_SPARE:
    s_lshl_b32 s4, s78, 2
    s_add_u32 s4, s4, s79
    s_sub_u32 s4, s4, 28
    s_lshl_b32 s5, s4, 6
    s_lshl_b32 s6, s3, 3
    s_add_u32 s5, s5, s6
    v_lshrrev_b32 v1, 4, v0
    v_and_b32 v2, 15, v0
    v_lshl_add_u32 v3, v1, 1, s5
    v_mul_u32_u24 v4, 896, v3
    v_lshl_add_u32 v4, v2, 4, v4
    v_mov_b32 v28, 0
    v_mov_b32 v29, 0
    v_mov_b32 v30, 0
    v_mov_b32 v31, 0
    v_mov_b32 v44, 0
    v_mov_b32 v45, 0
    v_mov_b32 v46, 0
    v_mov_b32 v47, 0
    v_mov_b32 v5, 65600
    v_mov_b32 v6, 0
    ds_write_b32 v5, v6
    s_waitcnt lgkmcnt(0)
    global_load_dwordx4 v[16:19], v4, s[16:17] offset:0
    global_load_dwordx4 v[32:35], v4, s[16:17] offset:896
    global_load_dwordx4 v[20:23], v4, s[16:17] offset:256
    global_load_dwordx4 v[36:39], v4, s[16:17] offset:1152
    global_load_dwordx4 v[24:27], v4, s[16:17] offset:512
    global_load_dwordx4 v[40:43], v4, s[16:17] offset:1408
    s_mov_b32 exec_lo, 0x00ff00ff
    s_mov_b32 exec_hi, 0x00ff00ff
    global_load_dwordx4 v[28:31], v4, s[16:17] offset:768
    global_load_dwordx4 v[44:47], v4, s[16:17] offset:1664
    s_mov_b64 exec, -1
    s_add_u32 s6, s44, 11024384
    s_addc_u32 s7, s45, 0
    s_load_dword s46, s[6:7], 0
    s_lshl_b32 s10, s3, 2
    v_and_b32 v8, 7, v2
    v_lshl_add_u32 v8, v8, 2, v1
    v_add_u32 v8, s10, v8
    v_and_b32 v8, 31, v8
    v_lshlrev_b32 v8, 2, v8
    v_lshl_add_u32 v8, v2, 10, v8
    v_add_u32 v9, 16384, v8
    v_add_u32 v10, 32768, v8
    v_add_u32 v11, 49152, v8
    s_mov_b32 s12, 0x3f803f80
    v_mov_b32 v48, 0
    v_mov_b32 v49, 0
    v_mov_b32 v50, 0
    v_mov_b32 v51, 0
    v_mov_b32 v52, 0
    v_mov_b32 v53, 0
    v_mov_b32 v54, 0
    v_mov_b32 v55, 0
    s_waitcnt lgkmcnt(0)
    s_mul_i32 s47, s46, 0x9E3779B1
    s_add_u32 s47, s47, 0x7F4A7C15
    s_waitcnt vmcnt(0)
    v_dot2c_f32_bf16 v48, s12, v16
    v_dot2c_f32_bf16 v52, s12, v32
    v_dot2c_f32_bf16 v50, v16, v16
    v_dot2c_f32_bf16 v54, v32, v32
    v_dot2c_f32_bf16 v49, s12, v17
    v_dot2c_f32_bf16 v53, s12, v33
    v_dot2c_f32_bf16 v51, v17, v17
    v_dot2c_f32_bf16 v55, v33, v33
    v_dot2c_f32_bf16 v48, s12, v18
    v_dot2c_f32_bf16 v52, s12, v34
    v_dot2c_f32_bf16 v50, v18, v18
    v_dot2c_f32_bf16 v54, v34, v34
    v_dot2c_f32_bf16 v49, s12, v19
    v_dot2c_f32_bf16 v53, s12, v35
    v_dot2c_f32_bf16 v51, v19, v19
    v_dot2c_f32_bf16 v55, v35, v35
    v_dot2c_f32_bf16 v48, s12, v20
    v_dot2c_f32_bf16 v52, s12, v36
    v_dot2c_f32_bf16 v50, v20, v20
    v_dot2c_f32_bf16 v54, v36, v36
    v_dot2c_f32_bf16 v49, s12, v21
    v_dot2c_f32_bf16 v53, s12, v37
    v_dot2c_f32_bf16 v51, v21, v21
    v_dot2c_f32_bf16 v55, v37, v37
    v_dot2c_f32_bf16 v48, s12, v22
    v_dot2c_f32_bf16 v52, s12, v38
    v_dot2c_f32_bf16 v50, v22, v22
    v_dot2c_f32_bf16 v54, v38, v38
    v_dot2c_f32_bf16 v49, s12, v23
    v_dot2c_f32_bf16 v53, s12, v39
    v_dot2c_f32_bf16 v51, v23, v23
    v_dot2c_f32_bf16 v55, v39, v39
    v_dot2c_f32_bf16 v48, s12, v24
    v_dot2c_f32_bf16 v52, s12, v40
    v_dot2c_f32_bf16 v50, v24, v24
    v_dot2c_f32_bf16 v54, v40, v40
    v_dot2c_f32_bf16 v49, s12, v25
    v_dot2c_f32_bf16 v53, s12, v41
    v_dot2c_f32_bf16 v51, v25, v25
    v_dot2c_f32_bf16 v55, v41, v41
    v_dot2c_f32_bf16 v48, s12, v26
    v_dot2c_f32_bf16 v52, s12, v42
    v_dot2c_f32_bf16 v50, v26, v26
    v_dot2c_f32_bf16 v54, v42, v42
    v_dot2c_f32_bf16 v49, s12, v27
    v_dot2c_f32_bf16 v53, s12, v43
    v_dot2c_f32_bf16 v51, v27, v27
    v_dot2c_f32_bf16 v55, v43, v43
    v_dot2c_f32_bf16 v48, s12, v28
    v_dot2c_f32_bf16 v52, s12, v44
    v_dot2c_f32_bf16 v50, v28, v28
    v_dot2c_f32_bf16 v54, v44, v44
    v_dot2c_f32_bf16 v49, s12, v29
    v_dot2c_f32_bf16 v53, s12, v45
    v_dot2c_f32_bf16 v51, v29, v29
    v_dot2c_f32_bf16 v55, v45, v45
    v_dot2c_f32_bf16 v48, s12, v30
    v_dot2c_f32_bf16 v52, s12, v46
    v_dot2c_f32_bf16 v50, v30, v30
    v_dot2c_f32_bf16 v54, v46, v46
    v_dot2c_f32_bf16 v49, s12, v31
    v_dot2c_f32_bf16 v53, s12, v47
    v_dot2c_f32_bf16 v51, v31, v31
    v_dot2c_f32_bf16 v55, v47, v47
    v_add_f32 v48, v48, v49
    s_nop 0
    v_add_f32 v50, v50, v51
    v_add_f32 v52, v52, v53
    v_add_f32 v54, v54, v55
    v_add_f32_dpp v48, v48, v48 quad_perm:[1,0,3,2] row_mask:0xf bank_mask:0xf
    v_add_f32_dpp v50, v50, v50 quad_perm:[1,0,3,2] row_mask:0xf bank_mask:0xf
    v_add_f32_dpp v52, v52, v52 quad_perm:[1,0,3,2] row_mask:0xf bank_mask:0xf
    v_add_f32_dpp v54, v54, v54 quad_perm:[1,0,3,2] row_mask:0xf bank_mask:0xf
    v_add_f32_dpp v48, v48, v48 quad_perm:[2,3,0,1] row_mask:0xf bank_mask:0xf
    v_add_f32_dpp v50, v50, v50 quad_perm:[2,3,0,1] row_mask:0xf bank_mask:0xf
    v_add_f32_dpp v52, v52, v52 quad_perm:[2,3,0,1] row_mask:0xf bank_mask:0xf
    v_add_f32_dpp v54, v54, v54 quad_perm:[2,3,0,1] row_mask:0xf bank_mask:0xf
    v_add_f32_dpp v48, v48, v48 row_half_mirror row_mask:0xf bank_mask:0xf
    v_add_f32_dpp v50, v50, v50 row_half_mirror row_mask:0xf bank_mask:0xf
    v_add_f32_dpp v52, v52, v52 row_half_mirror row_mask:0xf bank_mask:0xf
    v_add_f32_dpp v54, v54, v54 row_half_mirror row_mask:0xf bank_mask:0xf
    v_add_f32_dpp v48, v48, v48 row_mirror row_mask:0xf bank_mask:0xf
    v_add_f32_dpp v50, v50, v50 row_mirror row_mask:0xf bank_mask:0xf
    v_add_f32_dpp v52, v52, v52 row_mirror row_mask:0xf bank_mask:0xf
    v_add_f32_dpp v54, v54, v54 row_mirror row_mask:0xf bank_mask:0xf
    v_mul_f32 v48, 0x3b124925, v48
    v_mul_f32 v52, 0x3b124925, v52
    v_mul_f32 v50, 0x3b124925, v50
    v_mul_f32 v54, 0x3b124925, v54
    v_fma_f32 v50, -v48, v48, v50
    v_fma_f32 v54, -v52, v52, v54
    v_max_f32 v50, 0, v50
    v_max_f32 v54, 0, v54
    v_cvt_pk_bf16_f32 v56, v48, v48
    v_cvt_pk_bf16_f32 v62, v52, v52
    v_cvt_pk_bf16_f32 v57, v50, v50
    v_cvt_pk_bf16_f32 v63, v54, v54
    v_and_b32 v56, 0xffff0000, v56
    v_and_b32 v62, 0xffff0000, v62
    v_and_b32 v57, 0xffff0000, v57
    v_and_b32 v63, 0xffff0000, v63
    v_add_f32 v57, 0x3727c5ac, v57
    v_add_f32 v63, 0x3727c5ac, v63
    v_cvt_pk_bf16_f32 v57, v57, v57
    v_cvt_pk_bf16_f32 v63, v63, v63
    v_and_b32 v57, 0xffff0000, v57
    v_and_b32 v63, 0xffff0000, v63
    v_sqrt_f32 v57, v57
    v_sqrt_f32 v63, v63
    v_cvt_pk_bf16_f32 v57, v57, v57
    v_cvt_pk_bf16_f32 v63, v63, v63
    v_and_b32 v57, 0xffff0000, v57
    v_and_b32 v63, 0xffff0000, v63
    v_rcp_f32 v58, v57
    v_rcp_f32 v64, v63
    v_sub_f32 v60, v48, v56
    v_sub_f32 v66, v52, v62
    v_mul_f32 v61, v50, v58
    v_mul_f32 v67, v54, v64
    v_mul_f32 v60, v60, v58
    v_mul_f32 v66, v66, v64
    v_mul_f32 v61, v61, v58
    v_mul_f32 v67, v67, v64
    v_cvt_pk_bf16_f32 v60, v60, v60
    v_cvt_pk_bf16_f32 v66, v66, v66
    v_cvt_pk_bf16_f32 v61, v61, v61
    v_cvt_pk_bf16_f32 v67, v67, v67
    v_and_b32 v60, 0xffff0000, v60
    v_and_b32 v66, 0xffff0000, v66
    v_and_b32 v61, 0xffff0000, v61
    v_and_b32 v67, 0xffff0000, v67
    v_add_f32 v61, 0x3727c5ac, v61
    v_add_f32 v67, 0x3727c5ac, v67
    v_cvt_pk_bf16_f32 v61, v61, v61
    v_cvt_pk_bf16_f32 v67, v67, v67
    v_and_b32 v61, 0xffff0000, v61
    v_and_b32 v67, 0xffff0000, v67
    v_sqrt_f32 v61, v61
    v_sqrt_f32 v67, v67
    v_cvt_pk_bf16_f32 v61, v61, v61
    v_cvt_pk_bf16_f32 v67, v67, v67
    v_and_b32 v61, 0xffff0000, v61
    v_and_b32 v67, 0xffff0000, v67
    v_rcp_f32 v61, v61
    v_rcp_f32 v67, v67
    v_fma_f32 v60, v60, v57, v56
    v_fma_f32 v66, v66, v63, v62
    v_mul_f32 v61, v58, v61
    v_mul_f32 v67, v64, v67
    v_cmp_eq_u32 vcc, 1, v2
    s_nop 1
    v_cndmask_b32 v68, v61, v67, vcc
    v_cndmask_b32 v70, v60, v66, vcc
    v_mov_b32 v69, s47
    v_sub_f32 v70, 0, v70
    v_mov_b32 v71, s47
    v_add_u32 v12, v3, v2
    v_lshlrev_b32 v12, 4, v12
    v_add_u32 v12, 11026432, v12
    s_mov_b32 exec_lo, 0x00030003
    s_mov_b32 exec_hi, 0x00030003
    global_store_dwordx4 v12, v[68:71], s[44:45] sc1
    s_mov_b64 exec, -1
    v_mov_b32 v72, v58
    v_mov_b32 v73, v64
    v_mul_f32 v74, v56, v58
    v_mul_f32 v75, v62, v64
    v_sub_f32 v74, 0, v74
    v_sub_f32 v75, 0, v75
    s_lshl_b32 s10, s4, 3
    s_add_u32 s10, s10, s3
    s_mul_i32 s10, s10, 6272
    v_lshl_add_u32 v7, v0, 7, s10
    s_mov_b32 exec_lo, -1
    s_mov_b32 exec_hi, 0x1ffff
    global_load_dword v250, v7, s[36:37]
    s_mov_b64 exec, -1
    v_lshlrev_b32 v80, 16, v16
    v_lshlrev_b32 v81, 16, v32
    v_and_b32 v82, 0xffff0000, v16
    v_and_b32 v83, 0xffff0000, v32
    v_pk_fma_f32 v[80:81], v[80:81], v[72:73], v[74:75]
    v_pk_fma_f32 v[82:83], v[82:83], v[72:73], v[74:75]
    v_cvt_pk_bf16_f32 v84, v80, v81
    v_cvt_pk_bf16_f32 v85, v82, v83
    ds_write2_b32 v8, v84, v85 offset0:0 offset1:32
    v_lshlrev_b32 v88, 16, v17
    v_lshlrev_b32 v89, 16, v33
    v_and_b32 v90, 0xffff0000, v17
    v_and_b32 v91, 0xffff0000, v33
    v_pk_fma_f32 v[88:89], v[88:89], v[72:73], v[74:75]
    v_pk_fma_f32 v[90:91], v[90:91], v[72:73], v[74:75]
    v_cvt_pk_bf16_f32 v92, v88, v89
    v_cvt_pk_bf16_f32 v93, v90, v91
    ds_write2_b32 v8, v92, v93 offset0:64 offset1:96
    v_lshlrev_b32 v80, 16, v18
    v_lshlrev_b32 v81, 16, v34
    v_and_b32 v82, 0xffff0000, v18
    v_and_b32 v83, 0xffff0000, v34
    v_pk_fma_f32 v[80:81], v[80:81], v[72:73], v[74:75]
    v_pk_fma_f32 v[82:83], v[82:83], v[72:73], v[74:75]
    v_cvt_pk_bf16_f32 v84, v80, v81
    v_cvt_pk_bf16_f32 v85, v82, v83
    ds_write2_b32 v8, v84, v85 offset0:128 offset1:160
    v_lshlrev_b32 v88, 16, v19
    v_lshlrev_b32 v89, 16, v35
    v_and_b32 v90, 0xffff0000, v19
    v_and_b32 v91, 0xffff0000, v35
    v_pk_fma_f32 v[88:89], v[88:89], v[72:73], v[74:75]
    v_pk_fma_f32 v[90:91], v[90:91], v[72:73], v[74:75]
    v_cvt_pk_bf16_f32 v92, v88, v89
    v_cvt_pk_bf16_f32 v93, v90, v91
    ds_write2_b32 v8, v92, v93 offset0:192 offset1:224
    v_lshlrev_b32 v80, 16, v20
    v_lshlrev_b32 v81, 16, v36
    v_and_b32 v82, 0xffff0000, v20
    v_and_b32 v83, 0xffff0000, v36
    v_pk_fma_f32 v[80:81], v[80:81], v[72:73], v[74:75]
    v_pk_fma_f32 v[82:83], v[82:83], v[72:73], v[74:75]
    v_cvt_pk_bf16_f32 v84, v80, v81
    v_cvt_pk_bf16_f32 v85, v82, v83
    ds_write2_b32 v9, v84, v85 offset0:0 offset1:32
    v_lshlrev_b32 v88, 16, v21
    v_lshlrev_b32 v89, 16, v37
    v_and_b32 v90, 0xffff0000, v21
    v_and_b32 v91, 0xffff0000, v37
    v_pk_fma_f32 v[88:89], v[88:89], v[72:73], v[74:75]
    v_pk_fma_f32 v[90:91], v[90:91], v[72:73], v[74:75]
    v_cvt_pk_bf16_f32 v92, v88, v89
    v_cvt_pk_bf16_f32 v93, v90, v91
    ds_write2_b32 v9, v92, v93 offset0:64 offset1:96
    v_lshlrev_b32 v80, 16, v22
    v_lshlrev_b32 v81, 16, v38
    v_and_b32 v82, 0xffff0000, v22
    v_and_b32 v83, 0xffff0000, v38
    v_pk_fma_f32 v[80:81], v[80:81], v[72:73], v[74:75]
    v_pk_fma_f32 v[82:83], v[82:83], v[72:73], v[74:75]
    v_cvt_pk_bf16_f32 v84, v80, v81
    v_cvt_pk_bf16_f32 v85, v82, v83
    ds_write2_b32 v9, v84, v85 offset0:128 offset1:160
    v_lshlrev_b32 v88, 16, v23
    v_lshlrev_b32 v89, 16, v39
    v_and_b32 v90, 0xffff0000, v23
    v_and_b32 v91, 0xffff0000, v39
    v_pk_fma_f32 v[88:89], v[88:89], v[72:73], v[74:75]
    v_pk_fma_f32 v[90:91], v[90:91], v[72:73], v[74:75]
    v_cvt_pk_bf16_f32 v92, v88, v89
    v_cvt_pk_bf16_f32 v93, v90, v91
    ds_write2_b32 v9, v92, v93 offset0:192 offset1:224
    v_lshlrev_b32 v80, 16, v24
    v_lshlrev_b32 v81, 16, v40
    v_and_b32 v82, 0xffff0000, v24
    v_and_b32 v83, 0xffff0000, v40
    v_pk_fma_f32 v[80:81], v[80:81], v[72:73], v[74:75]
    v_pk_fma_f32 v[82:83], v[82:83], v[72:73], v[74:75]
    v_cvt_pk_bf16_f32 v84, v80, v81
    v_cvt_pk_bf16_f32 v85, v82, v83
    ds_write2_b32 v10, v84, v85 offset0:0 offset1:32
    v_lshlrev_b32 v88, 16, v25
    v_lshlrev_b32 v89, 16, v41
    v_and_b32 v90, 0xffff0000, v25
    v_and_b32 v91, 0xffff0000, v41
    v_pk_fma_f32 v[88:89], v[88:89], v[72:73], v[74:75]
    v_pk_fma_f32 v[90:91], v[90:91], v[72:73], v[74:75]
    v_cvt_pk_bf16_f32 v92, v88, v89
    v_cvt_pk_bf16_f32 v93, v90, v91
    ds_write2_b32 v10, v92, v93 offset0:64 offset1:96
    v_lshlrev_b32 v80, 16, v26
    v_lshlrev_b32 v81, 16, v42
    v_and_b32 v82, 0xffff0000, v26
    v_and_b32 v83, 0xffff0000, v42
    v_pk_fma_f32 v[80:81], v[80:81], v[72:73], v[74:75]
    v_pk_fma_f32 v[82:83], v[82:83], v[72:73], v[74:75]
    v_cvt_pk_bf16_f32 v84, v80, v81
    v_cvt_pk_bf16_f32 v85, v82, v83
    ds_write2_b32 v10, v84, v85 offset0:128 offset1:160
    v_lshlrev_b32 v88, 16, v27
    v_lshlrev_b32 v89, 16, v43
    v_and_b32 v90, 0xffff0000, v27
    v_and_b32 v91, 0xffff0000, v43
    v_pk_fma_f32 v[88:89], v[88:89], v[72:73], v[74:75]
    v_pk_fma_f32 v[90:91], v[90:91], v[72:73], v[74:75]
    v_cvt_pk_bf16_f32 v92, v88, v89
    v_cvt_pk_bf16_f32 v93, v90, v91
    ds_write2_b32 v10, v92, v93 offset0:192 offset1:224
    v_lshlrev_b32 v80, 16, v28
    v_lshlrev_b32 v81, 16, v44
    v_and_b32 v82, 0xffff0000, v28
    v_and_b32 v83, 0xffff0000, v44
    v_pk_fma_f32 v[80:81], v[80:81], v[72:73], v[74:75]
    v_pk_fma_f32 v[82:83], v[82:83], v[72:73], v[74:75]
    v_cvt_pk_bf16_f32 v84, v80, v81
    v_cvt_pk_bf16_f32 v85, v82, v83
    ds_write2_b32 v11, v84, v85 offset0:0 offset1:32
    v_lshlrev_b32 v88, 16, v29
    v_lshlrev_b32 v89, 16, v45
    v_and_b32 v90, 0xffff0000, v29
    v_and_b32 v91, 0xffff0000, v45
    v_pk_fma_f32 v[88:89], v[88:89], v[72:73], v[74:75]
    v_pk_fma_f32 v[90:91], v[90:91], v[72:73], v[74:75]
    v_cvt_pk_bf16_f32 v92, v88, v89
    v_cvt_pk_bf16_f32 v93, v90, v91
    ds_write2_b32 v11, v92, v93 offset0:64 offset1:96
    v_lshlrev_b32 v80, 16, v30
    v_lshlrev_b32 v81, 16, v46
    v_and_b32 v82, 0xffff0000, v30
    v_and_b32 v83, 0xffff0000, v46
    v_pk_fma_f32 v[80:81], v[80:81], v[72:73], v[74:75]
    v_pk_fma_f32 v[82:83], v[82:83], v[72:73], v[74:75]
    v_cvt_pk_bf16_f32 v84, v80, v81
    v_cvt_pk_bf16_f32 v85, v82, v83
    ds_write2_b32 v11, v84, v85 offset0:128 offset1:160
    v_lshlrev_b32 v88, 16, v31
    v_lshlrev_b32 v89, 16, v47
    v_and_b32 v90, 0xffff0000, v31
    v_and_b32 v91, 0xffff0000, v47
    v_pk_fma_f32 v[88:89], v[88:89], v[72:73], v[74:75]
    v_pk_fma_f32 v[90:91], v[90:91], v[72:73], v[74:75]
    v_cvt_pk_bf16_f32 v92, v88, v89
    v_cvt_pk_bf16_f32 v93, v90, v91
    ds_write2_b32 v11, v92, v93 offset0:192 offset1:224
    v_lshrrev_b32 v1, 3, v0
    v_and_b32 v2, 7, v0
    s_mul_i32 s10, s3, 56
    v_add_u32 v3, s10, v1
    v_lshlrev_b32 v4, 7, v3
    s_mul_i32 s11, s3, 7
    v_add_u32 v5, s11, v2
    v_lshlrev_b32 v6, 12, v3
    v_lshl_add_u32 v6, v2, 4, v6
    s_lshl_b32 s11, s4, 7
    s_add_u32 s11, s11, 7340032
    v_add_u32 v6, s11, v6
    v_add_u32 v16, 0, v5
    v_and_b32 v16, 7, v16
    v_lshl_add_u32 v16, v16, 4, v4
    v_add_u32 v17, 1, v5
    v_and_b32 v17, 7, v17
    v_lshl_add_u32 v17, v17, 4, v4
    v_add_u32 v18, 2, v5
    v_and_b32 v18, 7, v18
    v_lshl_add_u32 v18, v18, 4, v4
    v_add_u32 v19, 3, v5
    v_and_b32 v19, 7, v19
    v_lshl_add_u32 v19, v19, 4, v4
    v_add_u32 v20, 4, v5
    v_and_b32 v20, 7, v20
    v_lshl_add_u32 v20, v20, 4, v4
    v_add_u32 v21, 5, v5
    v_and_b32 v21, 7, v21
    v_lshl_add_u32 v21, v21, 4, v4
    v_add_u32 v22, 6, v5
    v_and_b32 v22, 7, v22
    v_lshl_add_u32 v22, v22, 4, v4
    s_waitcnt lgkmcnt(0)
    s_barrier
    s_cmp_ge_u32 s4, 7
    s_cbranch_scc1 SP_NOZ
    s_cmp_lg_u32 s3, 0
    s_cbranch_scc1 SP_NOZ
    s_lshl_b32 s10, s4, 7
    s_add_u32 s10, s10, 11063296
    v_mov_b32 v8, s10
    v_mov_b32 v9, 0
    s_mov_b64 exec, 1
    global_store_dword v8, v9, s[44:45] sc1
    s_mov_b64 exec, -1
SP_NOZ:
    ds_read_b128 v[32:35], v16 offset:0
    ds_read_b128 v[36:39], v17 offset:1024
    ds_read_b128 v[40:43], v18 offset:2048
    ds_read_b128 v[44:47], v19 offset:3072
    ds_read_b128 v[48:51], v20 offset:4096
    ds_read_b128 v[52:55], v21 offset:5120
    ds_read_b128 v[56:59], v22 offset:6144
    s_waitcnt lgkmcnt(6)
    global_store_dwordx4 v6, v[32:35], s[44:45] sc1
    v_add_u32 v6, 32768, v6
    s_waitcnt lgkmcnt(5)
    global_store_dwordx4 v6, v[36:39], s[44:45] sc1
    v_add_u32 v6, 32768, v6
    s_waitcnt lgkmcnt(4)
    global_store_dwordx4 v6, v[40:43], s[44:45] sc1
    v_add_u32 v6, 32768, v6
    s_waitcnt lgkmcnt(3)
    global_store_dwordx4 v6, v[44:47], s[44:45] sc1
    v_add_u32 v6, 32768, v6
    s_waitcnt lgkmcnt(2)
    global_store_dwordx4 v6, v[48:51], s[44:45] sc1
    v_add_u32 v6, 32768, v6
    s_waitcnt lgkmcnt(1)
    global_store_dwordx4 v6, v[52:55], s[44:45] sc1
    v_add_u32 v6, 32768, v6
    s_waitcnt lgkmcnt(0)
    global_store_dwordx4 v6, v[56:59], s[44:45] sc1
    s_mov_b32 s10, 128
    s_mov_b32 s11, 11010048
    s_waitcnt vmcnt(0)
    v_mov_b32 v8, 65600
    v_mov_b32 v9, 1
    s_mov_b64 exec, 1
    ds_add_rtn_u32 v9, v8, v9
    s_waitcnt lgkmcnt(0)
    v_cmp_eq_u32 vcc, 7, v9
    s_cbranch_vccz PUB_67
    v_mov_b32 v8, s10
    v_mov_b32 v9, 1
    global_atomic_add v9, v8, v9, s[42:43] sc0
    s_waitcnt vmcnt(0)
    v_and_b32 v9, 31, v9
    v_cmp_eq_u32 vcc, 31, v9
    s_cbranch_vccz PUB_67
    s_mov_b64 exec, 0xffffffff
    v_mbcnt_lo_u32_b32 v8, -1, 0
    v_lshl_add_u32 v8, v8, 7, s11
    v_mov_b32 v9, s47
    global_store_dword v8, v9, s[44:45] sc1
PUB_67:
    s_mov_b64 exec, -1
    s_barrier
    s_sub_u32 s10, s79, 28
    s_lshl_b32 s10, s10, 3
    s_add_u32 s10, s10, s3
    s_min_u32 s10, s10, 27
    s_mul_i32 s10, s10, 57344
    v_lshl_add_u32 v7, v0, 7, s10
    global_load_dword v240, v7, s[36:37]
    v_add_u32 v7, 8192, v7
    global_load_dword v241, v7, s[36:37]
    v_add_u32 v7, 8192, v7
    global_load_dword v242, v7, s[36:37]
    v_add_u32 v7, 8192, v7
    global_load_dword v243, v7, s[36:37]
    v_add_u32 v7, 8192, v7
    s_barrier
    global_load_dword v244, v7, s[36:37]
    v_add_u32 v7, 8192, v7
    global_load_dword v245, v7, s[36:37]
    v_add_u32 v7, 8192, v7
    global_load_dword v246, v7, s[36:37]
    s_waitcnt vmcnt(0)
    s_branch recurrent_scan__ssm_conv_s4d__mixer_channel_mlp__prompt_kernel_END
CF_2:
    s_sub_u32 s69, s69, 1
    s_cbranch_scc1 recurrent_scan__ssm_conv_s4d__mixer_channel_mlp__prompt_kernel_BAIL
    ds_read_b32 v249, v248
    s_waitcnt lgkmcnt(0)
    v_cmp_gt_u32 vcc, 1, v249
    s_cbranch_vccnz CF_2
    s_branch CFB_3
CF_4:
    s_sub_u32 s69, s69, 1
    s_cbranch_scc1 recurrent_scan__ssm_conv_s4d__mixer_channel_mlp__prompt_kernel_BAIL
    ds_read_b32 v249, v248
    s_waitcnt lgkmcnt(0)
    v_cmp_gt_u32 vcc, 2, v249
    s_cbranch_vccnz CF_4
    s_branch CFB_5
CF_6:
    s_sub_u32 s69, s69, 1
    s_cbranch_scc1 recurrent_scan__ssm_conv_s4d__mixer_channel_mlp__prompt_kernel_BAIL
    ds_read_b32 v249, v248
    s_waitcnt lgkmcnt(0)
    v_cmp_gt_u32 vcc, 3, v249
    s_cbranch_vccnz CF_6
    s_branch CFB_7
CF_8:
    s_sub_u32 s69, s69, 1
    s_cbranch_scc1 recurrent_scan__ssm_conv_s4d__mixer_channel_mlp__prompt_kernel_BAIL
    ds_read_b32 v249, v248
    s_waitcnt lgkmcnt(0)
    v_cmp_gt_u32 vcc, 4, v249
    s_cbranch_vccnz CF_8
    s_branch CFB_9
CF_10:
    s_sub_u32 s69, s69, 1
    s_cbranch_scc1 recurrent_scan__ssm_conv_s4d__mixer_channel_mlp__prompt_kernel_BAIL
    ds_read_b32 v249, v248
    s_waitcnt lgkmcnt(0)
    v_cmp_gt_u32 vcc, 5, v249
    s_cbranch_vccnz CF_10
    s_branch CFB_11
CF_12:
    s_sub_u32 s69, s69, 1
    s_cbranch_scc1 recurrent_scan__ssm_conv_s4d__mixer_channel_mlp__prompt_kernel_BAIL
    ds_read_b32 v249, v248
    s_waitcnt lgkmcnt(0)
    v_cmp_gt_u32 vcc, 6, v249
    s_cbranch_vccnz CF_12
    s_branch CFB_13
CF_14:
    s_sub_u32 s69, s69, 1
    s_cbranch_scc1 recurrent_scan__ssm_conv_s4d__mixer_channel_mlp__prompt_kernel_BAIL
    ds_read_b32 v249, v248
    s_waitcnt lgkmcnt(0)
    v_cmp_gt_u32 vcc, 7, v249
    s_cbranch_vccnz CF_14
    s_branch CFB_15
CF_16:
    s_sub_u32 s69, s69, 1
    s_cbranch_scc1 recurrent_scan__ssm_conv_s4d__mixer_channel_mlp__prompt_kernel_BAIL
    ds_read_b32 v249, v248
    s_waitcnt lgkmcnt(0)
    v_cmp_gt_u32 vcc, 8, v249
    s_cbranch_vccnz CF_16
    s_branch CFB_17
CF_18:
    s_sub_u32 s69, s69, 1
    s_cbranch_scc1 recurrent_scan__ssm_conv_s4d__mixer_channel_mlp__prompt_kernel_BAIL
    ds_read_b32 v249, v248
    s_waitcnt lgkmcnt(0)
    v_cmp_gt_u32 vcc, 9, v249
    s_cbranch_vccnz CF_18
    s_branch CFB_19
CF_20:
    s_sub_u32 s69, s69, 1
    s_cbranch_scc1 recurrent_scan__ssm_conv_s4d__mixer_channel_mlp__prompt_kernel_BAIL
    ds_read_b32 v249, v248
    s_waitcnt lgkmcnt(0)
    v_cmp_gt_u32 vcc, 10, v249
    s_cbranch_vccnz CF_20
    s_branch CFB_21
TG_22:
    s_sub_u32 s69, s69, 1
    s_cbranch_scc1 recurrent_scan__ssm_conv_s4d__mixer_channel_mlp__prompt_kernel_BAIL
    ds_read_b64 v[92:93], v94
    s_waitcnt lgkmcnt(0)
    s_branch TGB_23
CF_24:
    s_sub_u32 s69, s69, 1
    s_cbranch_scc1 recurrent_scan__ssm_conv_s4d__mixer_channel_mlp__prompt_kernel_BAIL
    ds_read_b32 v249, v248
    s_waitcnt lgkmcnt(0)
    v_cmp_gt_u32 vcc, 11, v249
    s_cbranch_vccnz CF_24
    s_branch CFB_25
CF_26:
    s_sub_u32 s69, s69, 1
    s_cbranch_scc1 recurrent_scan__ssm_conv_s4d__mixer_channel_mlp__prompt_kernel_BAIL
    ds_read_b32 v249, v248
    s_waitcnt lgkmcnt(0)
    v_cmp_gt_u32 vcc, 12, v249
    s_cbranch_vccnz CF_26
    s_branch CFB_27
CF_28:
    s_sub_u32 s69, s69, 1
    s_cbranch_scc1 recurrent_scan__ssm_conv_s4d__mixer_channel_mlp__prompt_kernel_BAIL
    ds_read_b32 v249, v248
    s_waitcnt lgkmcnt(0)
    v_cmp_gt_u32 vcc, 13, v249
    s_cbranch_vccnz CF_28
    s_branch CFB_29
STP_30:
    s_sub_u32 s69, s69, 1
    s_cbranch_scc1 recurrent_scan__ssm_conv_s4d__mixer_channel_mlp__prompt_kernel_BAIL
    s_sleep 1
    global_load_dwordx4 v[192:195], v2, s[44:45] sc1
    s_waitcnt vmcnt(0)
    s_branch STB_31
CF_32:
    s_sub_u32 s69, s69, 1
    s_cbranch_scc1 recurrent_scan__ssm_conv_s4d__mixer_channel_mlp__prompt_kernel_BAIL
    ds_read_b32 v249, v248
    s_waitcnt lgkmcnt(0)
    v_cmp_gt_u32 vcc, 14, v249
    s_cbranch_vccnz CF_32
    s_branch CFB_33
CF_34:
    s_sub_u32 s69, s69, 1
    s_cbranch_scc1 recurrent_scan__ssm_conv_s4d__mixer_channel_mlp__prompt_kernel_BAIL
    ds_read_b32 v249, v248
    s_waitcnt lgkmcnt(0)
    v_cmp_gt_u32 vcc, 15, v249
    s_cbranch_vccnz CF_34
    s_branch CFB_35
HS_36:
    buffer_store_dwordx4 v[240:243], v8, s[56:59], s10 offen sc1
    buffer_store_dwordx4 v[244:247], v8, s[56:59], s10 offen offset:1024 sc1
    s_branch HSB_37
HS_38:
    buffer_store_dwordx4 v[192:195], v8, s[56:59], s10 offen sc1
    buffer_store_dwordx4 v[196:199], v8, s[56:59], s10 offen offset:1024 sc1
    s_branch HSB_39
FS_40:
    global_store_dword v2, v3, s[44:45] offset:0 sc1
    s_branch FSB_41
HS_42:
    buffer_store_dwordx4 v[240:243], v8, s[56:59], s10 offen sc1
    buffer_store_dwordx4 v[244:247], v8, s[56:59], s10 offen offset:1024 sc1
    s_branch HSB_43
HS_44:
    buffer_store_dwordx4 v[192:195], v8, s[56:59], s10 offen sc1
    buffer_store_dwordx4 v[196:199], v8, s[56:59], s10 offen offset:1024 sc1
    s_branch HSB_45
PA_46:
    s_sub_u32 s69, s69, 1
    s_cbranch_scc1 recurrent_scan__ssm_conv_s4d__mixer_channel_mlp__prompt_kernel_BAIL
    global_load_dword v200, v1, s[44:45] sc1
    s_waitcnt vmcnt(0)
    s_branch PAB_47
FS_48:
    global_store_dword v2, v3, s[44:45] offset:4 sc1
    s_branch FSB_49
PB_50:
    s_sub_u32 s69, s69, 1
    s_cbranch_scc1 recurrent_scan__ssm_conv_s4d__mixer_channel_mlp__prompt_kernel_BAIL
    global_load_dword v2, v1, s[44:45] sc1
    s_waitcnt vmcnt(0)
    s_branch PBB_51
CF_52:
    s_sub_u32 s69, s69, 1
    s_cbranch_scc1 recurrent_scan__ssm_conv_s4d__mixer_channel_mlp__prompt_kernel_BAIL
    ds_read_b32 v249, v248
    s_waitcnt lgkmcnt(0)
    v_cmp_gt_u32 vcc, 100, v249
    s_cbranch_vccnz CF_52
    s_branch CFB_53
CV2_54:
    s_waitcnt vmcnt(0)
    v_cmp_ne_u32 vcc, s47, v3
    s_or_b32 s12, vcc_lo, vcc_hi
    s_cbranch_scc1 CV2F_56
    buffer_load_dwordx4 v[24:27], v5, s[56:59], 0 offen sc1
    s_mov_b32 s11, 32768
    buffer_load_dwordx4 v[28:31], v5, s[56:59], s11 offen sc1
    s_branch CV2B_55
CV2F_56:
    global_load_dword v3, v7, s[44:45] sc1
    s_branch CV2B_55
CVR_59:
    s_sub_u32 s69, s69, 1
    s_cbranch_scc1 recurrent_scan__ssm_conv_s4d__mixer_channel_mlp__prompt_kernel_BAIL
    global_load_dword v3, v7, s[44:45] sc1
CVS_57:
    s_waitcnt vmcnt(0)
    v_cmp_ne_u32 vcc, s47, v3
    s_cbranch_vccnz CVR_59
    buffer_load_dwordx4 v[24:27], v5, s[56:59], 0 offen sc1
    s_mov_b32 s11, 32768
    buffer_load_dwordx4 v[28:31], v5, s[56:59], s11 offen sc1
    s_branch CVB_58
KC_LNS:
    s_sub_u32 s69, s69, 1
    s_cbranch_scc1 recurrent_scan__ssm_conv_s4d__mixer_channel_mlp__prompt_kernel_BAIL
    v_mov_b32 v1, s80
    global_load_dword v237, v1, s[44:45] sc1
    s_waitcnt vmcnt(0)
    v_cmp_ne_u32 vcc, s47, v237
    s_cbranch_vccz KC_LNOK
    s_sleep 4
    s_branch KC_LNS
KC_LNOK:
    s_lshl_b32 s10, s72, 12
    s_lshl_b32 s11, s7, 11
    s_add_u32 s10, s10, s11
    s_add_u32 s10, s10, 7340032
    v_lshlrev_b32 v1, 4, v0
    buffer_load_dwordx4 v[172:175], v1, s[56:59], s10 offen sc1
    buffer_load_dwordx4 v[176:179], v1, s[56:59], s10 offen offset:1024 sc1
    s_branch KC_HAVEU
recurrent_scan__ssm_conv_s4d__mixer_channel_mlp__prompt_kernel_BAIL:
    s_mov_b64 exec, 1
    v_mov_b32 v1, 0
    v_mov_b32 v2, s2
    v_lshl_or_b32 v2, v2, 4, s3
    v_or_b32 v2, 0xbad00000, v2
    global_store_dword v1, v2, s[42:43]
    s_waitcnt vmcnt(0)
recurrent_scan__ssm_conv_s4d__mixer_channel_mlp__prompt_kernel_END:
    s_endpgm
L_CODE_END:
.section .rodata,"a"
.p2align 6
.amdhsa_kernel recurrent_scan__ssm_conv_s4d__mixer_channel_mlp__prompt_kernel
  .amdhsa_next_free_vgpr 256
  .amdhsa_next_free_sgpr 102
  .amdhsa_accum_offset 256
  .amdhsa_group_segment_fixed_size 0
  .amdhsa_kernarg_size 120
  .amdhsa_user_sgpr_count 2
  .amdhsa_user_sgpr_kernarg_segment_ptr 1
  .amdhsa_system_sgpr_workgroup_id_x 1
.end_amdhsa_kernel
```
